```python
import torch

def _softmax(x, axis=-1):
    return torch.softmax(x, dim=axis)
def _gelu(x):
    return torch.nn.functional.gelu(x, approximate="tanh")
def _silu(x):
    return torch.nn.functional.silu(x)
def _sigmoid(x):
    return torch.sigmoid(x)
def _layernorm(x, axis=-1, eps=1e-5):
    m = x.mean(dim=axis, keepdim=True)
    v = x.var(dim=axis, keepdim=True, unbiased=False)
    return (x - m) / torch.sqrt(v + eps)
def _scatter_add(tgt, idx, src, axis=0):
    return tgt.clone().index_add_(axis, idx, src)
def _segment_sum(src, seg, n):
    out = torch.zeros((n,) + src.shape[1:], dtype=src.dtype)
    return out.index_add_(0, seg, src)
def _pad(x, pw):
    flat = tuple(v for pair in reversed(pw) for v in pair)
    return torch.nn.functional.pad(x, flat)

kernel_name = 'parallel_sum__ssm_conv_h3__mixer_channel_mlp__prompt'

def setup_inputs():

    _w = (lambda a: (lambda t: t.to(torch.bfloat16) if t.is_floating_point() else t)(torch.as_tensor(a)))
    def _A_setup():
        B, S, D = 1, 2048, 512
        ks = 4
        return {
            "q": _w((lambda *s: torch.randn(*s, dtype=torch.bfloat16) * 0.05)(B, S, D)),
            "k": _w((lambda *s: torch.randn(*s, dtype=torch.bfloat16) * 0.2)(B, S, D)),
            "v": _w((lambda *s: torch.randn(*s, dtype=torch.bfloat16) * 0.2)(B, S, D)),
            "shift_k": _w((lambda *s: torch.randn(*s, dtype=torch.bfloat16) * 0.2)(D, ks) * 0.5),
            "ssm_k": _w((lambda *s: torch.randn(*s, dtype=torch.bfloat16) * 0.8)(D, S) * (1.0 / S ** 0.5)),
            "ssm_D": _w((lambda *s: torch.randn(*s, dtype=torch.bfloat16) * 0.2)(D)),
        }
    _A_in = _A_setup()

    def _B_setup():
        B, S, D, F = 1, 2048, 512, 1792
        return {
            "x": _w((lambda *s: torch.randn(*s, dtype=torch.bfloat16) * 0.05)(B, S, D)),
            "w1": _w((lambda *s: torch.randn(*s, dtype=torch.bfloat16) * 0.8)(D, F) * (D ** -0.5)),
            "b1": _w((lambda *s: torch.randn(*s, dtype=torch.bfloat16) * 0.4)(F)),
            "w2": _w((lambda *s: torch.randn(*s, dtype=torch.bfloat16) * 0.05)(F, D) * (F ** -0.5)),
            "b2": _w((lambda *s: torch.randn(*s, dtype=torch.bfloat16) * 0.05)(D)),
        }
    _B_in = _B_setup()

    return {
        "A_q": _A_in["q"],
        "A_k": _A_in["k"],
        "A_v": _A_in["v"],
        "A_shift_k": _A_in["shift_k"],
        "A_ssm_k": _A_in["ssm_k"],
        "A_ssm_D": _A_in["ssm_D"],
        "B_x": _B_in["x"],
        "B_w1": _B_in["w1"],
        "B_b1": _B_in["b1"],
        "B_w2": _B_in["w2"],
        "B_b2": _B_in["b2"],
    }

def reference(A_q, A_k, A_v, A_shift_k, A_ssm_k, A_ssm_D, B_x, B_w1, B_b1, B_w2, B_b2):
    def _A_ref(q, k, v, shift_k, ssm_k, ssm_D):
        B, S, D = q.shape
        ks = shift_k.shape[-1]
        k_pad = _pad(k, ((0, 0), (ks - 1, 0), (0, 0)))
        k_shift = torch.zeros_like(k)
        for t in range(ks):
            k_shift = k_shift + k_pad[:, t:t + S, :] * shift_k[:, ks - 1 - t][None, None, :]
        kv = k_shift * v
        L = 2 * S
        kv_pad = _pad(kv, ((0, 0), (0, S), (0, 0)))
        kf_pad = _pad(ssm_k, ((0, 0), (0, S)))
        kv_f = (lambda x, axes=(-2,-1): torch.fft.rfft2(x.float(), dim=axes))(kv_pad[:, None, :, :], axes=(1, 2))
        kf_f = (lambda x, axes=(-2,-1): torch.fft.rfft2(x.float(), dim=axes))(kf_pad[:, None, :], axes=(1, 2))
        kf_f = (lambda x, *d: x.permute(*d))(kf_f, 1, 2, 0)
        y_f = kv_f * kf_f[None, :, :, :]
        y = (lambda x, s, axes=(-2,-1): torch.fft.irfft2(x, s=s, dim=axes).to(torch.bfloat16))(y_f, (1, L), axes=(1, 2))[:, 0, :S, :]
        y = y + kv * ssm_D[None, None, :]
        return q * y

    def _B_ref(x, w1, b1, w2, b2):
        y = _layernorm(x, axis=-1)
        h = _gelu(torch.einsum("bsd,df->bsf", y, w1) + b1)
        return torch.einsum("bsf,fd->bsd", h, w2) + b2

    x = A_q
    xn = _layernorm(x, axis=-1)
    return x + _A_ref(xn, A_k, A_v, A_shift_k, A_ssm_k, A_ssm_D) + _B_ref(xn, B_w1, B_b1, B_w2, B_b2)
```

```asm
; @launch grid=(256,1,1) block=(512,1,1) lds=160640
.amdgcn_target "amdgcn-amd-amdhsa--gfx950"
.text
.globl parallel_sum__ssm_conv_h3__mixer_channel_mlp__prompt_kernel
.p2align 8
.type parallel_sum__ssm_conv_h3__mixer_channel_mlp__prompt_kernel,@function
parallel_sum__ssm_conv_h3__mixer_channel_mlp__prompt_kernel:
    s_cmp_ge_u32 s2, 256
    s_cbranch_scc1 L_end
    s_load_dwordx16 s[16:31], s[0:1], 0
    s_load_dwordx8 s[32:39], s[0:1], 64
    s_load_dwordx4 s[40:43], s[0:1], 96
    s_getpc_b64 s[14:15]
    s_bfe_u32 s11, s2, 0x20003
    s_lshl_b32 s11, s11, 7
    v_lshlrev_b32 v2, 9, v0
    v_add_u32 v2, s11, v2
    v_min_u32 v2, 25460, v2
    global_load_dword v254, v2, s[14:15]
    v_readfirstlane_b32 s3, v0
    v_and_b32 v1, 63, v0
    v_lshlrev_b32 v3, 2, v1
    v_add_u32 v3, 158080, v3
    v_mov_b32 v4, 0
    ds_write2st64_b32 v3, v4, v4 offset0:0 offset1:1
    s_lshr_b32 s3, s3, 6
    s_and_b32 s4, s2, 7
    s_lshr_b32 s5, s2, 3
    s_mul_i32 s11, s5, 37
    s_lshr_b32 s11, s11, 8
    s_mul_i32 s14, s11, 7
    s_sub_u32 s14, s5, s14
    s_lshr_b32 s15, s4, 1
    s_lshl_b32 s15, s15, 2
    s_add_u32 s6, s15, s11
    s_and_b32 s15, s4, 1
    s_mul_i32 s15, s15, 7
    s_add_u32 s7, s15, s14
    s_mul_i32 s11, s11, 4
    s_mul_i32 s14, s14, 2
    s_add_u32 s10, s11, s14
    s_lshr_b32 s10, s10, 1
    s_and_b32 s13, s3, 3
    v_lshrrev_b32 v4, 4, v1
    v_and_b32 v5, 3, v1
    v_bfe_u32 v6, v1, 2, 2
    v_and_b32 v9, 31, v1
    v_lshrrev_b32 v10, 5, v1
    s_barrier
    s_cmp_ge_u32 s3, 4
    s_cbranch_scc1 L_C
    s_setprio 2
    s_mov_b32 s58, 2097152
    s_mov_b32 s59, 0x20000
    s_mov_b32 s62, 2097152
    s_mov_b32 s63, 0x20000
    s_mov_b32 s66, 2097152
    s_mov_b32 s67, 0x20000
    s_mov_b32 s70, 4096
    s_mov_b32 s71, 0x20000
    s_lshl_b32 s11, s4, 8
    s_lshl_b32 s14, s5, 3
    s_add_u32 s11, s11, s14
    s_lshl_b32 s14, s13, 1
    s_add_u32 s93, s11, s14
    s_lshl_b32 s15, s93, 10
    v_lshlrev_b32 v16, 10, v10
    v_lshl_add_u32 v16, v9, 4, v16
    v_lshlrev_b32 v15, 4, v9
    s_lshr_b32 s94, s2, 5
    s_and_b32 s95, s2, 31
    s_lshl_b32 s11, s95, 16
    s_lshl_b32 s14, s94, 7
    s_add_u32 s11, s11, s14
    s_lshl_b32 s14, s13, 14
    s_add_u32 s11, s11, s14
    v_lshlrev_b32 v200, 13, v10
    v_lshl_add_u32 v200, v9, 2, v200
    v_add_u32 v200, s11, v200
    v_subrev_u32 v201, 3072, v200
    v_add_u32 v202, 4096, v200
    s_lshl_b32 s14, s94, 9
    v_lshlrev_b32 v207, 4, v9
    v_add_u32 v207, s14, v207
    s_waitcnt lgkmcnt(0)
    s_mov_b64 s[56:57], s[16:17]
    s_mov_b64 s[60:61], s[18:19]
    s_mov_b64 s[64:65], s[20:21]
    s_mov_b64 s[68:69], s[22:23]
    s_load_dwordx2 s[96:97], s[42:43], 0
    buffer_load_dwordx4 v[208:211], v16, s[56:59], s15 offen
    buffer_load_dwordx4 v[212:215], v16, s[56:59], s15 offen offset:512
    s_branch L_G2
L_C:
    s_mov_b32 s58, 2097152
    s_mov_b32 s59, 0x20000
    s_mov_b32 s82, 1835008
    s_mov_b32 s83, 0x20000
    v_and_b32 v12, 7, v1
    v_xor_b32 v12, v12, v4
    v_lshlrev_b32 v12, 4, v12
    v_lshrrev_b32 v13, 3, v1
    v_lshl_add_u32 v12, v13, 10, v12
    s_lshl_b32 s11, s6, 17
    s_lshl_b32 s14, s13, 15
    s_add_u32 s11, s11, s14
    v_add_u32 v12, s11, v12
    v_xor_b32 v13, 64, v12
    v_add_u32 v13, 0x2000, v13
    v_mul_u32_u24 v14, 3584, v6
    v_lshl_add_u32 v14, v4, 6, v14
    v_lshl_add_u32 v14, v5, 4, v14
    s_mul_i32 s11, s13, 57344
    s_lshl_b32 s14, s7, 8
    s_add_u32 s11, s11, s14
    v_add_u32 v14, s11, v14
    v_add_u32 v15, 14336, v14
    s_lshl_b32 s15, s13, 12
    s_waitcnt lgkmcnt(0)
    s_mov_b64 s[56:57], s[16:17]
    s_mov_b64 s[80:81], s[30:31]
    s_load_dwordx2 s[96:97], s[42:43], 0
    s_cmp_ge_u32 s5, 28
    s_cbranch_scc1 L_c_helper
    s_add_u32 s101, s10, 0
    s_and_b32 s101, s101, 7
    s_lshl_b32 s94, s101, 7
    s_mul_i32 s95, s101, 229376
    s_add_u32 m0, s15, 0
    s_nop 0
    buffer_load_dwordx4 v12, s[56:59], s94 offen  lds
    s_mov_b32 s46, 12255232
    s_mov_b32 s47, 0x20000
    s_mov_b64 s[44:45], s[42:43]
    s_mov_b32 s74, 2097152
    s_mov_b32 s75, 0x20000
    s_mov_b64 s[72:73], s[24:25]
    s_mov_b32 s78, 1024
    s_mov_b32 s79, 0x20000
    s_mov_b64 s[76:77], s[26:27]
    s_mov_b32 s54, 1835008
    s_mov_b32 s55, 0x20000
    s_mov_b64 s[52:53], s[34:35]
    s_mov_b32 s90, 1024
    s_add_u32 m0, s15, 1024
    s_nop 0
    buffer_load_dwordx4 v13, s[56:59], s94 offen  lds
    s_mov_b32 s91, 0x20000
    s_mov_b64 s[88:89], s[36:37]
    s_mov_b32 s50, 2097152
    s_mov_b32 s51, 0x20000
    s_mov_b64 s[48:49], s[38:39]
    s_lshr_b32 s11, s5, 2
    s_lshr_b32 s14, s4, 1
    s_lshl_b32 s8, s14, 3
    s_add_u32 s8, s8, s11
    s_and_b32 s11, s5, 3
    s_and_b32 s14, s4, 1
    s_lshl_b32 s9, s14, 2
    s_add_u32 s9, s9, s11
    s_add_u32 m0, s15, 16384
    s_nop 0
    buffer_load_dwordx4 v14, s[80:83], s95 offen  lds
    s_mul_i32 s11, s11, 0
    s_add_u32 s11, s11, 1
    s_lshr_b32 s12, s11, 1
    s_mov_b32 s92, 0xffff0000
    v_and_b32 v3, 15, v1
    v_lshrrev_b32 v7, 2, v1
    v_lshlrev_b32 v8, 4, v1
    v_lshl_add_u32 v11, v10, 2, v6
    v_lshlrev_b32 v11, 10, v11
    v_and_b32 v2, 1, v4
    v_lshl_add_u32 v11, v2, 6, v11
    v_lshl_add_u32 v11, v5, 4, v11
    s_lshl_b32 s11, s9, 7
    s_add_u32 m0, s15, 17408
    s_nop 0
    buffer_load_dwordx4 v15, s[80:83], s95 offen  lds
    v_add_u32 v11, s11, v11
    v_lshlrev_b32 v21, 6, v6
    v_lshl_add_u32 v21, v2, 5, v21
    v_lshl_add_u32 v21, v5, 3, v21
    s_lshl_b32 s11, s13, 2
    s_add_u32 s11, s11, 158080
    v_mov_b32 v60, s11
    v_lshlrev_b32 v61, 2, v5
    v_add_u32 v61, 158080, v61
    s_and_b32 s24, s13, 1
    s_lshr_b32 s25, s13, 1
    s_lshl_b32 s26, s2, 1
    s_add_u32 s26, s26, s25
    s_add_u32 s101, s10, 0
    s_and_b32 s101, s101, 7
    s_lshl_b32 s94, s101, 7
    s_mul_i32 s95, s101, 229376
    s_add_u32 s94, s94, 16384
    s_add_u32 s95, s95, 28672
    s_add_u32 m0, s15, 2048
    s_nop 0
    buffer_load_dwordx4 v12, s[56:59], s94 offen  lds
    s_mul_i32 s27, s25, 4224
    s_add_u32 s27, s27, 149632
    s_mul_i32 s28, s13, 4640
    s_add_u32 s28, s28, 131072
    s_mul_i32 s23, s13, 14
    s_add_u32 s22, s23, s12
    s_lshl_b32 s22, s22, 15
    s_add_u32 s23, s23, 14
    s_lshl_b32 s23, s23, 15
    s_lshl_b32 s29, s9, 7
    v_and_b32 v17, 1, v4
    v_mul_u32_u24 v17, 4224, v17
    v_lshl_add_u32 v17, v3, 2, v17
    s_add_u32 m0, s15, 3072
    s_nop 0
    buffer_load_dwordx4 v13, s[56:59], s94 offen  lds
    v_add_u32 v17, 149632, v17
    v_mov_b32 v44, 0
    v_mov_b32 v45, 0
    v_mov_b32 v46, 0
    v_mov_b32 v47, 0
    ds_write_b32 v17, v44
    s_lshr_b32 s18, s2, 5
    s_lshl_b32 s18, s18, 7
    s_lshl_b32 s11, s4, 12
    s_add_u32 s18, s18, s11
    s_add_u32 s18, s18, 4096
    s_add_u32 s19, s18, 64
    s_mul_i32 s35, s26, 4224
    s_add_u32 m0, s15, 18432
    s_nop 0
    buffer_load_dwordx4 v14, s[80:83], s95 offen  lds
    s_lshl_b32 s14, s24, 11
    s_add_u32 s35, s35, s14
    s_add_u32 s35, s35, 262144
    s_mul_i32 s36, s25, 9280
    s_add_u32 s36, s36, s14
    s_add_u32 s36, s36, 131072
    v_add_u32 v32, s36, v8
    s_add_u32 s36, s36, 4640
    v_add_u32 v30, s28, v8
    s_xor_b32 s21, s13, 1
    s_mul_i32 s21, s21, 4640
    s_add_u32 s21, s21, 131072
    v_add_u32 v26, s21, v8
    s_add_u32 m0, s15, 19456
    s_nop 0
    buffer_load_dwordx4 v15, s[80:83], s95 offen  lds
    v_xor_b32 v25, 4, v60
    v_lshlrev_b32 v33, 2, v3
    v_lshl_add_u32 v33, v4, 4, v33
    s_lshl_b32 s14, s24, 8
    s_add_u32 s11, s27, s14
    s_add_u32 s11, s11, 4
    v_add_u32 v33, s11, v33
    v_add_u32 v34, 1024, v33
    v_add_u32 v35, 2048, v33
    v_add_u32 v36, 3072, v33
    v_lshrrev_b32 v37, 1, v3
    v_sub_u32 v37, 7, v37
    v_lshlrev_b32 v37, 6, v37
    s_add_u32 s101, s10, 1
    s_and_b32 s101, s101, 7
    s_lshl_b32 s94, s101, 7
    s_mul_i32 s95, s101, 229376
    s_add_u32 m0, s15, 32768
    s_nop 0
    buffer_load_dwordx4 v12, s[56:59], s94 offen  lds
    v_lshl_add_u32 v37, v4, 4, v37
    v_and_b32 v2, 1, v1
    v_mul_u32_u24 v2, 4640, v2
    v_add_u32 v37, v37, v2
    s_mul_i32 s11, s25, 9280
    s_add_u32 s11, s11, s14
    s_add_u32 s11, s11, 131072
    v_add_u32 v37, s11, v37
    v_lshlrev_b32 v27, 3, v1
    v_add_u32 v27, s28, v27
    v_lshrrev_b32 v42, 3, v1
    s_lshl_b32 s11, s13, 3
    v_add_u32 v42, s11, v42
    s_add_u32 m0, s15, 33792
    s_nop 0
    buffer_load_dwordx4 v13, s[56:59], s94 offen  lds
    v_and_b32 v39, 7, v1
    v_lshlrev_b32 v43, 10, v42
    v_lshl_add_u32 v43, v39, 4, v43
    s_lshl_b32 s30, s8, 16
    s_add_u32 s30, s30, s29
    s_add_u32 s37, s30, 32768
    s_lshl_b32 s31, s8, 12
    s_add_u32 s31, s31, 86048
    v_lshlrev_b32 v31, 6, v42
    s_add_u32 m0, s15, 49152
    s_nop 0
    buffer_load_dwordx4 v14, s[80:83], s95 offen  lds
    s_add_u32 m0, s15, 50176
    s_nop 0
    buffer_load_dwordx4 v15, s[80:83], s95 offen  lds
    s_add_u32 s101, s10, 1
    s_and_b32 s101, s101, 7
    s_lshl_b32 s94, s101, 7
    s_mul_i32 s95, s101, 229376
    s_add_u32 s94, s94, 16384
    s_add_u32 s95, s95, 28672
    s_add_u32 m0, s15, 34816
    s_nop 0
    buffer_load_dwordx4 v12, s[56:59], s94 offen  lds
    s_add_u32 m0, s15, 35840
    s_nop 0
    buffer_load_dwordx4 v13, s[56:59], s94 offen  lds
    s_add_u32 m0, s15, 51200
    s_nop 0
    buffer_load_dwordx4 v14, s[80:83], s95 offen  lds
    s_add_u32 m0, s15, 52224
    s_nop 0
    buffer_load_dwordx4 v15, s[80:83], s95 offen  lds
    s_lshl_b32 s14, s26, 1
    buffer_load_ushort v40, off, s[76:79], s14
    v_lshlrev_b32 v2, 4, v39
    buffer_load_dwordx4 v[240:243], v2, s[88:91], s29 offen
    s_waitcnt lgkmcnt(0)
    s_mul_i32 s96, s96, 1664525
    s_add_u32 s96, s96, 1013904223
    s_cmp_eq_u32 s96, 0
    s_cselect_b32 s96, 1013904223, s96
    s_mul_i32 s97, s97, 22695477
    s_add_u32 s97, s97, 0x9e3779b9
    v_mov_b32 v62, s96
    v_mov_b32 v63, s97
    s_waitcnt vmcnt(10)
    s_barrier
    s_add_u32 s101, s10, 2
    s_and_b32 s101, s101, 7
    s_lshl_b32 s94, s101, 7
    s_mul_i32 s95, s101, 229376
    s_add_u32 m0, s15, 65536
    s_nop 0
    buffer_load_dwordx4 v12, s[56:59], s94 offen  lds
    s_add_u32 m0, s15, 66560
    s_nop 0
    buffer_load_dwordx4 v13, s[56:59], s94 offen  lds
    s_add_u32 m0, s15, 81920
    s_nop 0
    buffer_load_dwordx4 v14, s[80:83], s95 offen  lds
    s_add_u32 m0, s15, 82944
    s_nop 0
    buffer_load_dwordx4 v15, s[80:83], s95 offen  lds
    s_add_u32 s101, s10, 2
    s_and_b32 s101, s101, 7
    s_lshl_b32 s94, s101, 7
    s_mul_i32 s95, s101, 229376
    s_add_u32 s94, s94, 16384
    s_add_u32 s95, s95, 28672
    s_add_u32 m0, s15, 67584
    s_nop 0
    buffer_load_dwordx4 v12, s[56:59], s94 offen  lds
    s_add_u32 m0, s15, 68608
    s_nop 0
    buffer_load_dwordx4 v13, s[56:59], s94 offen  lds
    s_add_u32 m0, s15, 83968
    s_nop 0
    buffer_load_dwordx4 v14, s[80:83], s95 offen  lds
    s_add_u32 m0, s15, 84992
    s_nop 0
    buffer_load_dwordx4 v15, s[80:83], s95 offen  lds
    s_add_u32 s101, s10, 3
    s_and_b32 s101, s101, 7
    s_lshl_b32 s94, s101, 7
    s_mul_i32 s95, s101, 229376
    s_add_u32 m0, s15, 98304
    s_nop 0
    buffer_load_dwordx4 v12, s[56:59], s94 offen  lds
    s_add_u32 m0, s15, 99328
    s_nop 0
    buffer_load_dwordx4 v13, s[56:59], s94 offen  lds
    s_add_u32 m0, s15, 114688
    s_nop 0
    buffer_load_dwordx4 v14, s[80:83], s95 offen  lds
    s_add_u32 m0, s15, 115712
    s_nop 0
    buffer_load_dwordx4 v15, s[80:83], s95 offen  lds
    s_add_u32 s101, s10, 3
    s_and_b32 s101, s101, 7
    s_lshl_b32 s94, s101, 7
    s_mul_i32 s95, s101, 229376
    s_add_u32 s94, s94, 16384
    s_add_u32 s95, s95, 28672
    s_add_u32 m0, s15, 100352
    s_nop 0
    buffer_load_dwordx4 v12, s[56:59], s94 offen  lds
    s_add_u32 m0, s15, 101376
    s_nop 0
    buffer_load_dwordx4 v13, s[56:59], s94 offen  lds
    s_add_u32 m0, s15, 116736
    s_nop 0
    buffer_load_dwordx4 v14, s[80:83], s95 offen  lds
    s_add_u32 m0, s15, 117760
    s_nop 0
    buffer_load_dwordx4 v15, s[80:83], s95 offen  lds
    s_waitcnt vmcnt(18)
    s_barrier
    s_lshl_b32 s11, s6, 13
    s_lshl_b32 s14, s13, 11
    s_add_u32 s11, s11, s14
    s_add_u32 s11, s11, 86016
    s_add_u32 m0, s14, 139264
    s_nop 0
    buffer_load_dwordx4 v8, s[44:47], s11 offen offset:0 sc1 lds
    buffer_load_dwordx4 v8, s[44:47], s11 offen offset:1024 sc1 lds
    s_add_u32 s101, s10, 4
    s_and_b32 s101, s101, 7
    s_lshl_b32 s94, s101, 7
    s_mul_i32 s95, s101, 229376
    s_add_u32 m0, s15, 0
    s_nop 0
    buffer_load_dwordx4 v12, s[56:59], s94 offen  lds
    s_add_u32 m0, s15, 1024
    s_nop 0
    buffer_load_dwordx4 v13, s[56:59], s94 offen  lds
    s_add_u32 m0, s15, 16384
    s_nop 0
    buffer_load_dwordx4 v14, s[80:83], s95 offen  lds
    s_add_u32 m0, s15, 17408
    s_nop 0
    buffer_load_dwordx4 v15, s[80:83], s95 offen  lds
    s_waitcnt vmcnt(14)
    s_barrier
    s_add_u32 s101, s10, 4
    s_and_b32 s101, s101, 7
    s_lshl_b32 s94, s101, 7
    s_mul_i32 s95, s101, 229376
    s_add_u32 s94, s94, 16384
    s_add_u32 s95, s95, 28672
    s_add_u32 m0, s15, 2048
    s_nop 0
    buffer_load_dwordx4 v12, s[56:59], s94 offen  lds
    s_add_u32 m0, s15, 3072
    s_nop 0
    buffer_load_dwordx4 v13, s[56:59], s94 offen  lds
    s_add_u32 m0, s15, 18432
    s_nop 0
    buffer_load_dwordx4 v14, s[80:83], s95 offen  lds
    s_add_u32 m0, s15, 19456
    s_nop 0
    buffer_load_dwordx4 v15, s[80:83], s95 offen  lds
    s_add_u32 s101, s10, 5
    s_and_b32 s101, s101, 7
    s_lshl_b32 s94, s101, 7
    s_mul_i32 s95, s101, 229376
    s_add_u32 m0, s15, 32768
    s_nop 0
    buffer_load_dwordx4 v12, s[56:59], s94 offen  lds
    s_add_u32 m0, s15, 33792
    s_nop 0
    buffer_load_dwordx4 v13, s[56:59], s94 offen  lds
    s_add_u32 m0, s15, 49152
    s_nop 0
    buffer_load_dwordx4 v14, s[80:83], s95 offen  lds
    s_add_u32 m0, s15, 50176
    s_nop 0
    buffer_load_dwordx4 v15, s[80:83], s95 offen  lds
    s_waitcnt vmcnt(14)
    s_barrier
    s_add_u32 s101, s10, 5
    s_and_b32 s101, s101, 7
    s_lshl_b32 s94, s101, 7
    s_mul_i32 s95, s101, 229376
    s_add_u32 s94, s94, 16384
    s_add_u32 s95, s95, 28672
    s_add_u32 m0, s15, 34816
    s_nop 0
    buffer_load_dwordx4 v12, s[56:59], s94 offen  lds
    s_add_u32 m0, s15, 35840
    s_nop 0
    buffer_load_dwordx4 v13, s[56:59], s94 offen  lds
    s_add_u32 m0, s15, 51200
    s_nop 0
    buffer_load_dwordx4 v14, s[80:83], s95 offen  lds
    s_add_u32 m0, s15, 52224
    s_nop 0
    buffer_load_dwordx4 v15, s[80:83], s95 offen  lds
    s_add_u32 s101, s10, 6
    s_and_b32 s101, s101, 7
    s_lshl_b32 s94, s101, 7
    s_mul_i32 s95, s101, 229376
    s_add_u32 m0, s15, 65536
    s_nop 0
    buffer_load_dwordx4 v12, s[56:59], s94 offen  lds
    s_add_u32 m0, s15, 66560
    s_nop 0
    buffer_load_dwordx4 v13, s[56:59], s94 offen  lds
    s_add_u32 m0, s15, 81920
    s_nop 0
    buffer_load_dwordx4 v14, s[80:83], s95 offen  lds
    s_add_u32 m0, s15, 82944
    s_nop 0
    buffer_load_dwordx4 v15, s[80:83], s95 offen  lds
    s_waitcnt vmcnt(20)
    s_waitcnt vmcnt(12)
    s_barrier
    s_add_u32 s101, s10, 6
    s_and_b32 s101, s101, 7
    s_lshl_b32 s94, s101, 7
    s_mul_i32 s95, s101, 229376
    s_add_u32 s94, s94, 16384
    s_add_u32 s95, s95, 28672
    s_add_u32 m0, s15, 67584
    s_nop 0
    buffer_load_dwordx4 v12, s[56:59], s94 offen  lds
    s_add_u32 m0, s15, 68608
    s_nop 0
    buffer_load_dwordx4 v13, s[56:59], s94 offen  lds
    s_add_u32 m0, s15, 83968
    s_nop 0
    buffer_load_dwordx4 v14, s[80:83], s95 offen  lds
    s_add_u32 m0, s15, 84992
    s_nop 0
    buffer_load_dwordx4 v15, s[80:83], s95 offen  lds
    s_add_u32 s101, s10, 7
    s_and_b32 s101, s101, 7
    s_lshl_b32 s94, s101, 7
    s_mul_i32 s95, s101, 229376
    s_add_u32 m0, s15, 98304
    s_nop 0
    buffer_load_dwordx4 v12, s[56:59], s94 offen  lds
    s_add_u32 m0, s15, 99328
    s_nop 0
    buffer_load_dwordx4 v13, s[56:59], s94 offen  lds
    s_add_u32 m0, s15, 114688
    s_nop 0
    buffer_load_dwordx4 v14, s[80:83], s95 offen  lds
    s_add_u32 m0, s15, 115712
    s_nop 0
    buffer_load_dwordx4 v15, s[80:83], s95 offen  lds
    s_cmp_lg_u32 s13, 0
    s_cbranch_scc1 L_c_nofk
    s_lshl_b32 s34, s2, 2
    s_add_u32 s34, s34, 4096
    v_lshlrev_b32 v2, 12, v1
    s_mov_b64 exec, 0xff
    buffer_store_dword v62, v2, s[44:47], s34 offen sc1
    s_mov_b64 exec, -1
L_c_nofk:
    s_waitcnt vmcnt(12)
    s_barrier
    s_add_u32 s101, s10, 7
    s_and_b32 s101, s101, 7
    s_lshl_b32 s94, s101, 7
    s_mul_i32 s95, s101, 229376
    s_add_u32 s94, s94, 16384
    s_add_u32 s95, s95, 28672
    s_add_u32 m0, s15, 100352
    s_nop 0
    buffer_load_dwordx4 v12, s[56:59], s94 offen  lds
    s_add_u32 m0, s15, 101376
    s_nop 0
    buffer_load_dwordx4 v13, s[56:59], s94 offen  lds
    s_add_u32 m0, s15, 116736
    s_nop 0
    buffer_load_dwordx4 v14, s[80:83], s95 offen  lds
    s_add_u32 m0, s15, 117760
    s_nop 0
    buffer_load_dwordx4 v15, s[80:83], s95 offen  lds
    s_waitcnt vmcnt(8)
    s_barrier
L_c_join:
    s_setprio 3
    s_waitcnt vmcnt(0)
    ds_write_b32 v60, v62 offset:272
    v_lshlrev_b32 v41, 2, v4
    v_add_u32 v41, v41, v3
    v_sub_u32 v41, 15, v41
    s_lshl_b32 s11, s24, 8
    v_add_u32 v41, s11, v41
    v_cmp_eq_u32 vcc, 0, v41
    s_nop 1
    v_cndmask_b32 v244, 0, v40, vcc
    v_cmp_eq_u32 vcc, 1, v41
    s_nop 1
    v_cndmask_b32 v245, 0, v40, vcc
    v_cmp_eq_u32 vcc, 2, v41
    s_nop 1
    v_cndmask_b32 v246, 0, v40, vcc
    v_cmp_eq_u32 vcc, 3, v41
    s_nop 1
    v_cndmask_b32 v247, 0, v40, vcc
    s_add_u32 m0, s15, 0
    s_add_u32 s11, s22, 0
    buffer_load_dwordx4 v11, s[52:55], s11 offen lds
    s_add_u32 m0, s15, 1024
    s_add_u32 s11, s22, 8192
    buffer_load_dwordx4 v11, s[52:55], s11 offen lds
    s_add_u32 m0, s15, 2048
    s_add_u32 s11, s22, 16384
    buffer_load_dwordx4 v11, s[52:55], s11 offen lds
    s_add_u32 m0, s15, 3072
    s_add_u32 s11, s22, 24576
    buffer_load_dwordx4 v11, s[52:55], s11 offen lds
    s_add_u32 s22, s22, 32768
    s_sub_u32 s11, s22, 458752
    s_cmp_ge_u32 s22, s23
    s_cselect_b32 s22, s11, s22
    s_add_u32 m0, s15, 16384
    s_add_u32 s11, s22, 0
    buffer_load_dwordx4 v11, s[52:55], s11 offen lds
    s_add_u32 m0, s15, 17408
    s_add_u32 s11, s22, 8192
    buffer_load_dwordx4 v11, s[52:55], s11 offen lds
    s_add_u32 m0, s15, 18432
    s_add_u32 s11, s22, 16384
    buffer_load_dwordx4 v11, s[52:55], s11 offen lds
    s_add_u32 m0, s15, 19456
    s_add_u32 s11, s22, 24576
    buffer_load_dwordx4 v11, s[52:55], s11 offen lds
    s_add_u32 s22, s22, 32768
    s_sub_u32 s11, s22, 458752
    s_cmp_ge_u32 s22, s23
    s_cselect_b32 s22, s11, s22
    s_add_u32 m0, s15, 32768
    s_add_u32 s11, s22, 0
    buffer_load_dwordx4 v11, s[52:55], s11 offen lds
    s_add_u32 m0, s15, 33792
    s_add_u32 s11, s22, 8192
    buffer_load_dwordx4 v11, s[52:55], s11 offen lds
    s_add_u32 m0, s15, 34816
    s_add_u32 s11, s22, 16384
    buffer_load_dwordx4 v11, s[52:55], s11 offen lds
    s_add_u32 m0, s15, 35840
    s_add_u32 s11, s22, 24576
    buffer_load_dwordx4 v11, s[52:55], s11 offen lds
    s_add_u32 s22, s22, 32768
    s_sub_u32 s11, s22, 458752
    s_cmp_ge_u32 s22, s23
    s_cselect_b32 s22, s11, s22
    s_add_u32 m0, s15, 49152
    s_add_u32 s11, s22, 0
    buffer_load_dwordx4 v11, s[52:55], s11 offen lds
    s_add_u32 m0, s15, 50176
    s_add_u32 s11, s22, 8192
    buffer_load_dwordx4 v11, s[52:55], s11 offen lds
    s_add_u32 m0, s15, 51200
    s_add_u32 s11, s22, 16384
    buffer_load_dwordx4 v11, s[52:55], s11 offen lds
    s_add_u32 m0, s15, 52224
    s_add_u32 s11, s22, 24576
    buffer_load_dwordx4 v11, s[52:55], s11 offen lds
    s_add_u32 s22, s22, 32768
    s_sub_u32 s11, s22, 458752
    s_cmp_ge_u32 s22, s23
    s_cselect_b32 s22, s11, s22
    buffer_load_dwordx4 v[224:227], v43, s[56:59], s30 offen
    buffer_load_dwordx4 v[228:231], v43, s[56:59], s37 offen
    buffer_load_dwordx4 v[232:235], v31, s[44:47], s31 offen sc1
    buffer_load_dwordx4 v[236:239], v31, s[44:47], s31 offen offset:2048 sc1
    s_lshl_b32 s11, s26, 12
    s_lshl_b32 s14, s24, 11
    s_add_u32 s11, s11, s14
    s_add_u32 s14, s14, s27
    s_add_u32 m0, s14, 64
    s_nop 0
    buffer_load_dwordx4 v8, s[72:75], s11 offen offset:0  lds
    s_lshl_b32 s11, s26, 12
    s_lshl_b32 s14, s24, 11
    s_add_u32 s11, s11, s14
    s_add_u32 s14, s14, s27
    s_add_u32 m0, s14, 64
    s_nop 0
    buffer_load_dwordx4 v8, s[72:75], s11 offen offset:1024  lds
    s_cmp_lg_u32 s13, 1
    s_cbranch_scc1 L_c_fki
    s_buffer_load_dwordx16 s[60:75], s[44:47], s18 glc
    s_buffer_load_dwordx16 s[76:91], s[44:47], s19 glc
L_c_fki:
    s_waitcnt vmcnt(4)
    s_mov_b32 s100, 400000
L_lw_1:
    ds_read_b32 v2, v61 offset:240
    s_waitcnt lgkmcnt(0)
    v_cmp_ne_u32 vcc, s96, v2
    s_cbranch_vccz L_lwd_2
    s_sub_u32 s100, s100, 1
    s_cbranch_scc1 L_lwd_2
    s_sleep 1
    s_branch L_lw_1
L_lwd_2:
    s_add_u32 m0, s15, 65536
    s_add_u32 s11, s22, 0
    buffer_load_dwordx4 v11, s[52:55], s11 offen lds
    s_add_u32 m0, s15, 66560
    s_add_u32 s11, s22, 8192
    buffer_load_dwordx4 v11, s[52:55], s11 offen lds
    s_add_u32 m0, s15, 67584
    s_add_u32 s11, s22, 16384
    buffer_load_dwordx4 v11, s[52:55], s11 offen lds
    s_add_u32 m0, s15, 68608
    s_add_u32 s11, s22, 24576
    buffer_load_dwordx4 v11, s[52:55], s11 offen lds
    s_add_u32 s22, s22, 32768
    s_sub_u32 s11, s22, 458752
    s_cmp_ge_u32 s22, s23
    s_cselect_b32 s22, s11, s22
    s_cmp_lg_u32 s13, 1
    s_cbranch_scc1 L_c_fkw
    s_mov_b32 s100, 40000
    s_mov_b32 s98, s96
    s_mov_b32 s99, s96
    s_branch L_spw_6
L_spr_5:
    s_sub_u32 s100, s100, 1
    s_cbranch_scc1 L_spd_4
    s_sleep 2
L_sp_3:
    s_buffer_load_dwordx16 s[60:75], s[44:47], s18 glc
    s_buffer_load_dwordx16 s[76:91], s[44:47], s19 glc
L_spw_6:
    s_waitcnt lgkmcnt(0)
    s_cmp_eq_u64 s[60:61], s[98:99]
    s_cbranch_scc0 L_spr_5
    s_cmp_eq_u64 s[62:63], s[98:99]
    s_cbranch_scc0 L_spr_5
    s_cmp_eq_u64 s[64:65], s[98:99]
    s_cbranch_scc0 L_spr_5
    s_cmp_eq_u64 s[66:67], s[98:99]
    s_cbranch_scc0 L_spr_5
    s_cmp_eq_u64 s[68:69], s[98:99]
    s_cbranch_scc0 L_spr_5
    s_cmp_eq_u64 s[70:71], s[98:99]
    s_cbranch_scc0 L_spr_5
    s_cmp_eq_u64 s[72:73], s[98:99]
    s_cbranch_scc0 L_spr_5
    s_cmp_eq_u64 s[74:75], s[98:99]
    s_cbranch_scc0 L_spr_5
    s_cmp_eq_u64 s[76:77], s[98:99]
    s_cbranch_scc0 L_spr_5
    s_cmp_eq_u64 s[78:79], s[98:99]
    s_cbranch_scc0 L_spr_5
    s_cmp_eq_u64 s[80:81], s[98:99]
    s_cbranch_scc0 L_spr_5
    s_cmp_eq_u64 s[82:83], s[98:99]
    s_cbranch_scc0 L_spr_5
    s_cmp_eq_u64 s[84:85], s[98:99]
    s_cbranch_scc0 L_spr_5
    s_cmp_eq_u64 s[86:87], s[98:99]
    s_cbranch_scc0 L_spr_5
    s_cmp_eq_u64 s[88:89], s[98:99]
    s_cbranch_scc0 L_spr_5
    s_cmp_eq_u64 s[90:91], s[98:99]
    s_cbranch_scc0 L_spr_5
L_spd_4:
    ds_write_b32 v60, v62 offset:320
L_c_fkw:
    v_mov_b32 v41, 158084
    s_mov_b32 s100, 400000
L_lw_7:
    ds_read_b32 v2, v41 offset:320
    s_waitcnt lgkmcnt(0)
    v_cmp_ne_u32 vcc, s96, v2
    s_cbranch_vccz L_lwd_8
    s_sub_u32 s100, s100, 1
    s_cbranch_scc1 L_lwd_8
    s_sleep 1
    s_branch L_lw_7
L_lwd_8:
    s_mov_b32 m0, s36
    ds_write_b64 v27, v[44:45] offset:4096
    buffer_load_dwordx4 v8, s[44:47], s35 offen offset:0 sc1 lds
    buffer_load_dwordx4 v8, s[44:47], s35 offen offset:1024 sc1 lds
    s_waitcnt vmcnt(4)
    s_add_u32 m0, s15, 81920
    s_add_u32 s11, s22, 0
    buffer_load_dwordx4 v11, s[52:55], s11 offen lds
    s_add_u32 m0, s15, 82944
    s_add_u32 s11, s22, 8192
    buffer_load_dwordx4 v11, s[52:55], s11 offen lds
    s_add_u32 m0, s15, 83968
    s_add_u32 s11, s22, 16384
    buffer_load_dwordx4 v11, s[52:55], s11 offen lds
    s_add_u32 m0, s15, 84992
    s_add_u32 s11, s22, 24576
    buffer_load_dwordx4 v11, s[52:55], s11 offen lds
    s_add_u32 s22, s22, 32768
    s_sub_u32 s11, s22, 458752
    s_cmp_ge_u32 s22, s23
    s_cselect_b32 s22, s11, s22
    s_waitcnt vmcnt(4)
    ds_write_b32 v60, v62 offset:80
    s_mov_b32 s100, 400000
L_lw_9:
    ds_read_b32 v2, v25 offset:80
    s_waitcnt lgkmcnt(0)
    v_cmp_ne_u32 vcc, s96, v2
    s_cbranch_vccz L_lwd_10
    s_sub_u32 s100, s100, 1
    s_cbranch_scc1 L_lwd_10
    s_sleep 1
    s_branch L_lw_9
L_lwd_10:
    ds_read_b128 v[64:67], v32 offset:4640
    ds_read_b32 v68, v32 offset:4656
    ds_read_b128 v[72:75], v32 offset:5664
    ds_read_b32 v76, v32 offset:5680
    s_waitcnt lgkmcnt(0)
    v_alignbyte_b32 v80, v65, v64, 2
    v_alignbyte_b32 v81, v66, v65, 2
    v_alignbyte_b32 v82, v67, v66, 2
    v_alignbyte_b32 v83, v68, v67, 2
    ds_write_b128 v32, v[80:83] offset:0
    v_alignbyte_b32 v84, v73, v72, 2
    v_alignbyte_b32 v85, v74, v73, 2
    v_alignbyte_b32 v86, v75, v74, 2
    v_alignbyte_b32 v87, v76, v75, 2
    ds_write_b128 v32, v[84:87] offset:1024
    ds_write_b32 v60, v62 offset:160
L_c_join2:
    s_mov_b32 s100, 400000
L_lw_11:
    ds_read_b32 v2, v25 offset:160
    s_waitcnt lgkmcnt(0)
    v_cmp_ne_u32 vcc, s96, v2
    s_cbranch_vccz L_lwd_12
    s_sub_u32 s100, s100, 1
    s_cbranch_scc1 L_lwd_12
    s_sleep 1
    s_branch L_lw_11
L_lwd_12:
    ds_read_b128 v[160:163], v37 offset:3584
    ds_read2_b32 v[96:97], v33 offset0:0 offset1:1
    ds_read2_b32 v[98:99], v33 offset0:2 offset1:3
    ds_read_b128 v[164:167], v37 offset:3072
    ds_read2_b32 v[100:101], v33 offset0:128 offset1:129
    ds_read2_b32 v[102:103], v33 offset0:130 offset1:131
    ds_read_b128 v[168:171], v37 offset:2560
    ds_read2_b32 v[104:105], v34 offset0:0 offset1:1
    ds_read2_b32 v[106:107], v34 offset0:2 offset1:3
    ds_read_b128 v[172:175], v37 offset:2048
    ds_read2_b32 v[108:109], v34 offset0:128 offset1:129
    ds_read2_b32 v[110:111], v34 offset0:130 offset1:131
    ds_read_b128 v[176:179], v37 offset:1536
    ds_read2_b32 v[112:113], v35 offset0:0 offset1:1
    ds_read2_b32 v[114:115], v35 offset0:2 offset1:3
    ds_read_b128 v[180:183], v37 offset:1024
    ds_read2_b32 v[116:117], v35 offset0:128 offset1:129
    ds_read2_b32 v[118:119], v35 offset0:130 offset1:131
    ds_read_b128 v[184:187], v37 offset:512
    ds_read2_b32 v[120:121], v36 offset0:0 offset1:1
    ds_read2_b32 v[122:123], v36 offset0:2 offset1:3
    ds_read_b128 v[188:191], v37 offset:0
    ds_read2_b32 v[124:125], v36 offset0:128 offset1:129
    ds_read2_b32 v[126:127], v36 offset0:130 offset1:131
    s_waitcnt vmcnt(0)
    ds_write_b32 v60, v62
    s_setprio 0
    s_mov_b32 s100, 400000
L_lw_13:
    ds_read_b32 v2, v60 offset:64
    s_waitcnt lgkmcnt(0)
    v_cmp_ne_u32 vcc, s96, v2
    s_cbranch_vccz L_lwd_14
    s_sub_u32 s100, s100, 1
    s_cbranch_scc1 L_lwd_14
    s_sleep 1
    s_branch L_lw_13
L_lwd_14:
    s_waitcnt lgkmcnt(0)
    s_setprio 1
    v_mfma_f32_16x16x32_bf16 v[64:67], v[244:247], v[160:163], 0
    v_mfma_f32_16x16x32_bf16 v[68:71], v[244:247], v[164:167], 0
    v_mfma_f32_16x16x32_bf16 v[72:75], v[244:247], v[168:171], 0
    v_mfma_f32_16x16x32_bf16 v[76:79], v[244:247], v[172:175], 0
    v_mfma_f32_16x16x32_bf16 v[80:83], v[244:247], v[176:179], 0
    v_mfma_f32_16x16x32_bf16 v[84:87], v[244:247], v[180:183], 0
    v_mfma_f32_16x16x32_bf16 v[88:91], v[244:247], v[184:187], 0
    v_mfma_f32_16x16x32_bf16 v[92:95], v[244:247], v[188:191], 0
    v_mfma_f32_16x16x32_bf16 v[64:67], v[96:99], v[160:163], v[64:67]
    ds_read_b128 v[192:195], v37 offset:3648
    v_mfma_f32_16x16x32_bf16 v[68:71], v[96:99], v[164:167], v[68:71]
    ds_read2_b32 v[128:129], v33 offset0:16 offset1:17
    v_mfma_f32_16x16x32_bf16 v[72:75], v[96:99], v[168:171], v[72:75]
    ds_read2_b32 v[130:131], v33 offset0:18 offset1:19
    v_mfma_f32_16x16x32_bf16 v[76:79], v[96:99], v[172:175], v[76:79]
    ds_read_b128 v[196:199], v37 offset:3136
    v_mfma_f32_16x16x32_bf16 v[80:83], v[96:99], v[176:179], v[80:83]
    ds_read2_b32 v[132:133], v33 offset0:144 offset1:145
    v_mfma_f32_16x16x32_bf16 v[84:87], v[96:99], v[180:183], v[84:87]
    ds_read2_b32 v[134:135], v33 offset0:146 offset1:147
    v_mfma_f32_16x16x32_bf16 v[88:91], v[96:99], v[184:187], v[88:91]
    ds_read_b128 v[200:203], v37 offset:2624
    v_mfma_f32_16x16x32_bf16 v[92:95], v[96:99], v[188:191], v[92:95]
    ds_read2_b32 v[136:137], v34 offset0:16 offset1:17
    v_mfma_f32_16x16x32_bf16 v[68:71], v[100:103], v[160:163], v[68:71]
    ds_read2_b32 v[138:139], v34 offset0:18 offset1:19
    v_mfma_f32_16x16x32_bf16 v[72:75], v[100:103], v[164:167], v[72:75]
    ds_read_b128 v[204:207], v37 offset:2112
    v_mfma_f32_16x16x32_bf16 v[76:79], v[100:103], v[168:171], v[76:79]
    ds_read2_b32 v[140:141], v34 offset0:144 offset1:145
    v_mfma_f32_16x16x32_bf16 v[80:83], v[100:103], v[172:175], v[80:83]
    ds_read2_b32 v[142:143], v34 offset0:146 offset1:147
    v_mfma_f32_16x16x32_bf16 v[84:87], v[100:103], v[176:179], v[84:87]
    ds_read_b128 v[208:211], v37 offset:1600
    v_mfma_f32_16x16x32_bf16 v[88:91], v[100:103], v[180:183], v[88:91]
    ds_read2_b32 v[144:145], v35 offset0:16 offset1:17
    v_mfma_f32_16x16x32_bf16 v[92:95], v[100:103], v[184:187], v[92:95]
    ds_read2_b32 v[146:147], v35 offset0:18 offset1:19
    v_mfma_f32_16x16x32_bf16 v[72:75], v[104:107], v[160:163], v[72:75]
    ds_read_b128 v[212:215], v37 offset:1088
    v_mfma_f32_16x16x32_bf16 v[76:79], v[104:107], v[164:167], v[76:79]
    ds_read2_b32 v[148:149], v35 offset0:144 offset1:145
    v_mfma_f32_16x16x32_bf16 v[80:83], v[104:107], v[168:171], v[80:83]
    ds_read2_b32 v[150:151], v35 offset0:146 offset1:147
    v_mfma_f32_16x16x32_bf16 v[84:87], v[104:107], v[172:175], v[84:87]
    ds_read_b128 v[216:219], v37 offset:576
    v_mfma_f32_16x16x32_bf16 v[88:91], v[104:107], v[176:179], v[88:91]
    ds_read2_b32 v[152:153], v36 offset0:16 offset1:17
    v_mfma_f32_16x16x32_bf16 v[92:95], v[104:107], v[180:183], v[92:95]
    ds_read2_b32 v[154:155], v36 offset0:18 offset1:19
    v_mfma_f32_16x16x32_bf16 v[76:79], v[108:111], v[160:163], v[76:79]
    ds_read_b128 v[220:223], v37 offset:64
    v_mfma_f32_16x16x32_bf16 v[80:83], v[108:111], v[164:167], v[80:83]
    ds_read2_b32 v[156:157], v36 offset0:144 offset1:145
    v_mfma_f32_16x16x32_bf16 v[84:87], v[108:111], v[168:171], v[84:87]
    ds_read2_b32 v[158:159], v36 offset0:146 offset1:147
    v_mfma_f32_16x16x32_bf16 v[88:91], v[108:111], v[172:175], v[88:91]
    v_mfma_f32_16x16x32_bf16 v[92:95], v[108:111], v[176:179], v[92:95]
    v_mfma_f32_16x16x32_bf16 v[80:83], v[112:115], v[160:163], v[80:83]
    v_mfma_f32_16x16x32_bf16 v[84:87], v[112:115], v[164:167], v[84:87]
    v_mfma_f32_16x16x32_bf16 v[88:91], v[112:115], v[168:171], v[88:91]
    v_mfma_f32_16x16x32_bf16 v[92:95], v[112:115], v[172:175], v[92:95]
    v_mfma_f32_16x16x32_bf16 v[84:87], v[116:119], v[160:163], v[84:87]
    v_mfma_f32_16x16x32_bf16 v[88:91], v[116:119], v[164:167], v[88:91]
    v_mfma_f32_16x16x32_bf16 v[92:95], v[116:119], v[168:171], v[92:95]
    v_mfma_f32_16x16x32_bf16 v[88:91], v[120:123], v[160:163], v[88:91]
    v_mfma_f32_16x16x32_bf16 v[92:95], v[120:123], v[164:167], v[92:95]
    v_mfma_f32_16x16x32_bf16 v[92:95], v[124:127], v[160:163], v[92:95]
    s_waitcnt lgkmcnt(0)
    v_mfma_f32_16x16x32_bf16 v[64:67], v[128:131], v[192:195], v[64:67]
    ds_read_b128 v[160:163], v37 offset:3712
    v_mfma_f32_16x16x32_bf16 v[68:71], v[128:131], v[196:199], v[68:71]
    ds_read2_b32 v[96:97], v33 offset0:32 offset1:33
    v_mfma_f32_16x16x32_bf16 v[72:75], v[128:131], v[200:203], v[72:75]
    ds_read2_b32 v[98:99], v33 offset0:34 offset1:35
    v_mfma_f32_16x16x32_bf16 v[76:79], v[128:131], v[204:207], v[76:79]
    ds_read_b128 v[164:167], v37 offset:3200
    v_mfma_f32_16x16x32_bf16 v[80:83], v[128:131], v[208:211], v[80:83]
    ds_read2_b32 v[100:101], v33 offset0:160 offset1:161
    v_mfma_f32_16x16x32_bf16 v[84:87], v[128:131], v[212:215], v[84:87]
    ds_read2_b32 v[102:103], v33 offset0:162 offset1:163
    v_mfma_f32_16x16x32_bf16 v[88:91], v[128:131], v[216:219], v[88:91]
    ds_read_b128 v[168:171], v37 offset:2688
    v_mfma_f32_16x16x32_bf16 v[92:95], v[128:131], v[220:223], v[92:95]
    ds_read2_b32 v[104:105], v34 offset0:32 offset1:33
    v_mfma_f32_16x16x32_bf16 v[68:71], v[132:135], v[192:195], v[68:71]
    ds_read2_b32 v[106:107], v34 offset0:34 offset1:35
    v_mfma_f32_16x16x32_bf16 v[72:75], v[132:135], v[196:199], v[72:75]
    ds_read_b128 v[172:175], v37 offset:2176
    v_mfma_f32_16x16x32_bf16 v[76:79], v[132:135], v[200:203], v[76:79]
    ds_read2_b32 v[108:109], v34 offset0:160 offset1:161
    v_mfma_f32_16x16x32_bf16 v[80:83], v[132:135], v[204:207], v[80:83]
    ds_read2_b32 v[110:111], v34 offset0:162 offset1:163
    v_mfma_f32_16x16x32_bf16 v[84:87], v[132:135], v[208:211], v[84:87]
    ds_read_b128 v[176:179], v37 offset:1664
    v_mfma_f32_16x16x32_bf16 v[88:91], v[132:135], v[212:215], v[88:91]
    ds_read2_b32 v[112:113], v35 offset0:32 offset1:33
    v_mfma_f32_16x16x32_bf16 v[92:95], v[132:135], v[216:219], v[92:95]
    ds_read2_b32 v[114:115], v35 offset0:34 offset1:35
    v_mfma_f32_16x16x32_bf16 v[72:75], v[136:139], v[192:195], v[72:75]
    ds_read_b128 v[180:183], v37 offset:1152
    v_mfma_f32_16x16x32_bf16 v[76:79], v[136:139], v[196:199], v[76:79]
    ds_read2_b32 v[116:117], v35 offset0:160 offset1:161
    v_mfma_f32_16x16x32_bf16 v[80:83], v[136:139], v[200:203], v[80:83]
    ds_read2_b32 v[118:119], v35 offset0:162 offset1:163
    v_mfma_f32_16x16x32_bf16 v[84:87], v[136:139], v[204:207], v[84:87]
    ds_read_b128 v[184:187], v37 offset:640
    v_mfma_f32_16x16x32_bf16 v[88:91], v[136:139], v[208:211], v[88:91]
    ds_read2_b32 v[120:121], v36 offset0:32 offset1:33
    v_mfma_f32_16x16x32_bf16 v[92:95], v[136:139], v[212:215], v[92:95]
    ds_read2_b32 v[122:123], v36 offset0:34 offset1:35
    v_mfma_f32_16x16x32_bf16 v[76:79], v[140:143], v[192:195], v[76:79]
    ds_read_b128 v[188:191], v37 offset:128
    v_mfma_f32_16x16x32_bf16 v[80:83], v[140:143], v[196:199], v[80:83]
    ds_read2_b32 v[124:125], v36 offset0:160 offset1:161
    v_mfma_f32_16x16x32_bf16 v[84:87], v[140:143], v[200:203], v[84:87]
    ds_read2_b32 v[126:127], v36 offset0:162 offset1:163
    v_mfma_f32_16x16x32_bf16 v[88:91], v[140:143], v[204:207], v[88:91]
    v_mfma_f32_16x16x32_bf16 v[92:95], v[140:143], v[208:211], v[92:95]
    v_mfma_f32_16x16x32_bf16 v[80:83], v[144:147], v[192:195], v[80:83]
    v_mfma_f32_16x16x32_bf16 v[84:87], v[144:147], v[196:199], v[84:87]
    v_mfma_f32_16x16x32_bf16 v[88:91], v[144:147], v[200:203], v[88:91]
    v_mfma_f32_16x16x32_bf16 v[92:95], v[144:147], v[204:207], v[92:95]
    v_mfma_f32_16x16x32_bf16 v[84:87], v[148:151], v[192:195], v[84:87]
    v_mfma_f32_16x16x32_bf16 v[88:91], v[148:151], v[196:199], v[88:91]
    v_mfma_f32_16x16x32_bf16 v[92:95], v[148:151], v[200:203], v[92:95]
    v_mfma_f32_16x16x32_bf16 v[88:91], v[152:155], v[192:195], v[88:91]
    v_mfma_f32_16x16x32_bf16 v[92:95], v[152:155], v[196:199], v[92:95]
    v_mfma_f32_16x16x32_bf16 v[92:95], v[156:159], v[192:195], v[92:95]
    s_waitcnt lgkmcnt(0)
    v_mfma_f32_16x16x32_bf16 v[64:67], v[96:99], v[160:163], v[64:67]
    ds_read_b128 v[192:195], v37 offset:3776
    v_mfma_f32_16x16x32_bf16 v[68:71], v[96:99], v[164:167], v[68:71]
    ds_read2_b32 v[128:129], v33 offset0:48 offset1:49
    v_mfma_f32_16x16x32_bf16 v[72:75], v[96:99], v[168:171], v[72:75]
    ds_read2_b32 v[130:131], v33 offset0:50 offset1:51
    v_mfma_f32_16x16x32_bf16 v[76:79], v[96:99], v[172:175], v[76:79]
    ds_read_b128 v[196:199], v37 offset:3264
    v_mfma_f32_16x16x32_bf16 v[80:83], v[96:99], v[176:179], v[80:83]
    ds_read2_b32 v[132:133], v33 offset0:176 offset1:177
    v_mfma_f32_16x16x32_bf16 v[84:87], v[96:99], v[180:183], v[84:87]
    ds_read2_b32 v[134:135], v33 offset0:178 offset1:179
    v_mfma_f32_16x16x32_bf16 v[88:91], v[96:99], v[184:187], v[88:91]
    ds_read_b128 v[200:203], v37 offset:2752
    v_mfma_f32_16x16x32_bf16 v[92:95], v[96:99], v[188:191], v[92:95]
    ds_read2_b32 v[136:137], v34 offset0:48 offset1:49
    v_mfma_f32_16x16x32_bf16 v[68:71], v[100:103], v[160:163], v[68:71]
    ds_read2_b32 v[138:139], v34 offset0:50 offset1:51
    v_mfma_f32_16x16x32_bf16 v[72:75], v[100:103], v[164:167], v[72:75]
    ds_read_b128 v[204:207], v37 offset:2240
    v_mfma_f32_16x16x32_bf16 v[76:79], v[100:103], v[168:171], v[76:79]
    ds_read2_b32 v[140:141], v34 offset0:176 offset1:177
    v_mfma_f32_16x16x32_bf16 v[80:83], v[100:103], v[172:175], v[80:83]
    ds_read2_b32 v[142:143], v34 offset0:178 offset1:179
    v_mfma_f32_16x16x32_bf16 v[84:87], v[100:103], v[176:179], v[84:87]
    ds_read_b128 v[208:211], v37 offset:1728
    v_mfma_f32_16x16x32_bf16 v[88:91], v[100:103], v[180:183], v[88:91]
    ds_read2_b32 v[144:145], v35 offset0:48 offset1:49
    v_mfma_f32_16x16x32_bf16 v[92:95], v[100:103], v[184:187], v[92:95]
    ds_read2_b32 v[146:147], v35 offset0:50 offset1:51
    v_mfma_f32_16x16x32_bf16 v[72:75], v[104:107], v[160:163], v[72:75]
    ds_read_b128 v[212:215], v37 offset:1216
    v_mfma_f32_16x16x32_bf16 v[76:79], v[104:107], v[164:167], v[76:79]
    ds_read2_b32 v[148:149], v35 offset0:176 offset1:177
    v_mfma_f32_16x16x32_bf16 v[80:83], v[104:107], v[168:171], v[80:83]
    ds_read2_b32 v[150:151], v35 offset0:178 offset1:179
    v_mfma_f32_16x16x32_bf16 v[84:87], v[104:107], v[172:175], v[84:87]
    ds_read_b128 v[216:219], v37 offset:704
    v_mfma_f32_16x16x32_bf16 v[88:91], v[104:107], v[176:179], v[88:91]
    ds_read2_b32 v[152:153], v36 offset0:48 offset1:49
    v_mfma_f32_16x16x32_bf16 v[92:95], v[104:107], v[180:183], v[92:95]
    ds_read2_b32 v[154:155], v36 offset0:50 offset1:51
    v_mfma_f32_16x16x32_bf16 v[76:79], v[108:111], v[160:163], v[76:79]
    ds_read_b128 v[220:223], v37 offset:192
    v_mfma_f32_16x16x32_bf16 v[80:83], v[108:111], v[164:167], v[80:83]
    ds_read2_b32 v[156:157], v36 offset0:176 offset1:177
    v_mfma_f32_16x16x32_bf16 v[84:87], v[108:111], v[168:171], v[84:87]
    ds_read2_b32 v[158:159], v36 offset0:178 offset1:179
    v_mfma_f32_16x16x32_bf16 v[88:91], v[108:111], v[172:175], v[88:91]
    v_mfma_f32_16x16x32_bf16 v[92:95], v[108:111], v[176:179], v[92:95]
    v_mfma_f32_16x16x32_bf16 v[80:83], v[112:115], v[160:163], v[80:83]
    v_mfma_f32_16x16x32_bf16 v[84:87], v[112:115], v[164:167], v[84:87]
    v_mfma_f32_16x16x32_bf16 v[88:91], v[112:115], v[168:171], v[88:91]
    v_mfma_f32_16x16x32_bf16 v[92:95], v[112:115], v[172:175], v[92:95]
    v_mfma_f32_16x16x32_bf16 v[84:87], v[116:119], v[160:163], v[84:87]
    v_mfma_f32_16x16x32_bf16 v[88:91], v[116:119], v[164:167], v[88:91]
    v_mfma_f32_16x16x32_bf16 v[92:95], v[116:119], v[168:171], v[92:95]
    v_mfma_f32_16x16x32_bf16 v[88:91], v[120:123], v[160:163], v[88:91]
    v_mfma_f32_16x16x32_bf16 v[92:95], v[120:123], v[164:167], v[92:95]
    v_mfma_f32_16x16x32_bf16 v[92:95], v[124:127], v[160:163], v[92:95]
    s_waitcnt lgkmcnt(0)
    ds_write_b32 v60, v62 offset:96
    v_mfma_f32_16x16x32_bf16 v[64:67], v[128:131], v[192:195], v[64:67]
    v_mfma_f32_16x16x32_bf16 v[68:71], v[128:131], v[196:199], v[68:71]
    v_mfma_f32_16x16x32_bf16 v[72:75], v[128:131], v[200:203], v[72:75]
    v_mfma_f32_16x16x32_bf16 v[76:79], v[128:131], v[204:207], v[76:79]
    v_mfma_f32_16x16x32_bf16 v[80:83], v[128:131], v[208:211], v[80:83]
    v_mfma_f32_16x16x32_bf16 v[84:87], v[128:131], v[212:215], v[84:87]
    v_mfma_f32_16x16x32_bf16 v[88:91], v[128:131], v[216:219], v[88:91]
    v_mfma_f32_16x16x32_bf16 v[92:95], v[128:131], v[220:223], v[92:95]
    v_mfma_f32_16x16x32_bf16 v[68:71], v[132:135], v[192:195], v[68:71]
    v_mfma_f32_16x16x32_bf16 v[72:75], v[132:135], v[196:199], v[72:75]
    v_mfma_f32_16x16x32_bf16 v[76:79], v[132:135], v[200:203], v[76:79]
    v_mfma_f32_16x16x32_bf16 v[80:83], v[132:135], v[204:207], v[80:83]
    v_mfma_f32_16x16x32_bf16 v[84:87], v[132:135], v[208:211], v[84:87]
    v_mfma_f32_16x16x32_bf16 v[88:91], v[132:135], v[212:215], v[88:91]
    v_mfma_f32_16x16x32_bf16 v[92:95], v[132:135], v[216:219], v[92:95]
    v_mfma_f32_16x16x32_bf16 v[72:75], v[136:139], v[192:195], v[72:75]
    v_mfma_f32_16x16x32_bf16 v[76:79], v[136:139], v[196:199], v[76:79]
    v_mfma_f32_16x16x32_bf16 v[80:83], v[136:139], v[200:203], v[80:83]
    v_mfma_f32_16x16x32_bf16 v[84:87], v[136:139], v[204:207], v[84:87]
    v_mfma_f32_16x16x32_bf16 v[88:91], v[136:139], v[208:211], v[88:91]
    v_mfma_f32_16x16x32_bf16 v[92:95], v[136:139], v[212:215], v[92:95]
    v_mfma_f32_16x16x32_bf16 v[76:79], v[140:143], v[192:195], v[76:79]
    v_mfma_f32_16x16x32_bf16 v[80:83], v[140:143], v[196:199], v[80:83]
    v_mfma_f32_16x16x32_bf16 v[84:87], v[140:143], v[200:203], v[84:87]
    v_mfma_f32_16x16x32_bf16 v[88:91], v[140:143], v[204:207], v[88:91]
    v_mfma_f32_16x16x32_bf16 v[92:95], v[140:143], v[208:211], v[92:95]
    v_mfma_f32_16x16x32_bf16 v[80:83], v[144:147], v[192:195], v[80:83]
    v_mfma_f32_16x16x32_bf16 v[84:87], v[144:147], v[196:199], v[84:87]
    v_mfma_f32_16x16x32_bf16 v[88:91], v[144:147], v[200:203], v[88:91]
    v_mfma_f32_16x16x32_bf16 v[92:95], v[144:147], v[204:207], v[92:95]
    v_mfma_f32_16x16x32_bf16 v[84:87], v[148:151], v[192:195], v[84:87]
    v_mfma_f32_16x16x32_bf16 v[88:91], v[148:151], v[196:199], v[88:91]
    v_mfma_f32_16x16x32_bf16 v[92:95], v[148:151], v[200:203], v[92:95]
    v_mfma_f32_16x16x32_bf16 v[88:91], v[152:155], v[192:195], v[88:91]
    v_mfma_f32_16x16x32_bf16 v[92:95], v[152:155], v[196:199], v[92:95]
    v_mfma_f32_16x16x32_bf16 v[92:95], v[156:159], v[192:195], v[92:95]
    s_mov_b32 s100, 400000
L_lw_15:
    ds_read_b32 v2, v25 offset:96
    s_waitcnt lgkmcnt(0)
    v_cmp_ne_u32 vcc, s96, v2
    s_cbranch_vccz L_lwd_16
    s_sub_u32 s100, s100, 1
    s_cbranch_scc1 L_lwd_16
    s_sleep 1
    s_branch L_lw_15
L_lwd_16:
    s_cmp_lg_u32 s24, 0
    s_cbranch_scc1 L_cx1
    ds_write_b128 v30, v[80:83] offset:0
    ds_write_b128 v30, v[84:87] offset:1024
    ds_write_b128 v30, v[88:91] offset:2048
    ds_write_b128 v30, v[92:95] offset:3072
    ds_write_b32 v60, v62 offset:112
    v_mov_b32 v128, v64
    v_mov_b32 v129, v65
    v_mov_b32 v130, v66
    v_mov_b32 v131, v67
    v_mov_b32 v132, v68
    v_mov_b32 v133, v69
    v_mov_b32 v134, v70
    v_mov_b32 v135, v71
    v_mov_b32 v136, v72
    v_mov_b32 v137, v73
    v_mov_b32 v138, v74
    v_mov_b32 v139, v75
    v_mov_b32 v140, v76
    v_mov_b32 v141, v77
    v_mov_b32 v142, v78
    v_mov_b32 v143, v79
    s_branch L_cx2
L_cx1:
    ds_write_b128 v30, v[64:67] offset:0
    ds_write_b128 v30, v[68:71] offset:1024
    ds_write_b128 v30, v[72:75] offset:2048
    ds_write_b128 v30, v[76:79] offset:3072
    ds_write_b32 v60, v62 offset:112
    v_mov_b32 v128, v80
    v_mov_b32 v129, v81
    v_mov_b32 v130, v82
    v_mov_b32 v131, v83
    v_mov_b32 v132, v84
    v_mov_b32 v133, v85
    v_mov_b32 v134, v86
    v_mov_b32 v135, v87
    v_mov_b32 v136, v88
    v_mov_b32 v137, v89
    v_mov_b32 v138, v90
    v_mov_b32 v139, v91
    v_mov_b32 v140, v92
    v_mov_b32 v141, v93
    v_mov_b32 v142, v94
    v_mov_b32 v143, v95
L_cx2:
    s_mov_b32 s100, 400000
L_lw_17:
    ds_read_b32 v2, v25 offset:112
    s_waitcnt lgkmcnt(0)
    v_cmp_ne_u32 vcc, s96, v2
    s_cbranch_vccz L_lwd_18
    s_sub_u32 s100, s100, 1
    s_cbranch_scc1 L_lwd_18
    s_sleep 1
    s_branch L_lw_17
L_lwd_18:
    ds_read_b128 v[96:99], v26 offset:0
    ds_read_b128 v[100:103], v26 offset:1024
    ds_read_b128 v[104:107], v26 offset:2048
    ds_read_b128 v[108:111], v26 offset:3072
    s_lshl_b32 s11, s26, 12
    s_lshl_b32 s14, s24, 11
    s_add_u32 s11, s11, s14
    s_add_u32 s11, s11, 2424832
    s_waitcnt lgkmcnt(3)
    v_add_f32 v128, v128, v96
    v_add_f32 v129, v129, v97
    v_add_f32 v130, v130, v98
    v_add_f32 v131, v131, v99
    v_cvt_pk_bf16_f32 v48, v128, v129
    v_cvt_pk_bf16_f32 v49, v130, v131
    s_waitcnt lgkmcnt(2)
    v_add_f32 v132, v132, v100
    v_add_f32 v133, v133, v101
    v_add_f32 v134, v134, v102
    v_add_f32 v135, v135, v103
    v_cvt_pk_bf16_f32 v50, v132, v133
    v_cvt_pk_bf16_f32 v51, v134, v135
    s_nop 0
    v_permlane16_swap_b32 v48, v50
    v_permlane16_swap_b32 v49, v51
    buffer_store_dwordx4 v[48:51], v8, s[44:47], s11 offen offset:0 sc1
    s_waitcnt lgkmcnt(1)
    v_add_f32 v136, v136, v104
    v_add_f32 v137, v137, v105
    v_add_f32 v138, v138, v106
    v_add_f32 v139, v139, v107
    v_cvt_pk_bf16_f32 v52, v136, v137
    v_cvt_pk_bf16_f32 v53, v138, v139
    s_waitcnt lgkmcnt(0)
    v_add_f32 v140, v140, v108
    v_add_f32 v141, v141, v109
    v_add_f32 v142, v142, v110
    v_add_f32 v143, v143, v111
    v_cvt_pk_bf16_f32 v54, v140, v141
    v_cvt_pk_bf16_f32 v55, v142, v143
    s_nop 0
    v_permlane16_swap_b32 v52, v54
    v_permlane16_swap_b32 v53, v55
    buffer_store_dwordx4 v[52:55], v8, s[44:47], s11 offen offset:1024 sc1
    ds_write_b32 v60, v62 offset:368
    s_setprio 1
    s_mov_b32 s28, s21
    s_lshl_b32 s22, s2, 2
    s_add_u32 s22, s22, 53248
    v_lshlrev_b32 v36, 12, v1
    s_mov_b32 s100, 40000
L_c_st:
    v_cmp_ne_u32 vcc, s96, v235
    v_cmp_ne_u32 s[16:17], s96, v239
    s_nop 0
    s_or_b64 vcc, vcc, s[16:17]
    s_cbranch_scc0 L_c_std
    s_sub_u32 s100, s100, 1
    s_cbranch_scc1 L_c_std
    buffer_load_dwordx4 v[232:235], v31, s[44:47], s31 offen sc1
    buffer_load_dwordx4 v[236:239], v31, s[44:47], s31 offen offset:2048 sc1
    s_waitcnt vmcnt(0)
    s_branch L_c_st
L_c_std:
    s_lshl_b32 s11, s9, 7
    s_lshr_b32 s14, s8, 2
    s_lshl_b32 s14, s14, 12
    s_add_u32 s11, s11, s14
    s_add_u32 s94, s11, 53248
    s_add_u32 s95, s94, 64
    v_lshrrev_b32 v35, 3, v1
    v_lshlrev_b32 v35, 12, v35
    v_bfe_u32 v2, v1, 2, 1
    v_lshl_add_u32 v35, v2, 9, v35
    v_lshl_add_u32 v35, v5, 4, v35
    s_lshl_b32 s19, s9, 18
    s_lshr_b32 s14, s8, 3
    s_lshl_b32 s14, s14, 10
    s_add_u32 s19, s19, s14
    s_and_b32 s14, s8, 7
    s_lshl_b32 s14, s14, 6
    s_add_u32 s19, s19, s14
    s_add_u32 s19, s19, 2424832
    v_lshlrev_b32 v37, 7, v7
    v_lshl_add_u32 v37, v5, 3, v37
    v_add_u32 v37, s28, v37
    v_lshlrev_b32 v38, 6, v39
    v_bfe_u32 v2, v1, 3, 1
    v_lshl_add_u32 v38, v2, 5, v38
    v_lshl_add_u32 v38, v4, 3, v38
    v_add_u32 v38, s28, v38
    v_lshrrev_b32 v34, 1, v39
    v_xor_b32 v34, 1, v34
    v_mul_u32_u24 v34, 4640, v34
    v_lshl_add_u32 v34, v42, 5, v34
    v_and_b32 v2, 1, v39
    v_lshl_add_u32 v34, v2, 4, v34
    v_add_u32 v34, 133120, v34
    v_and_b32 v2, 7, v42
    v_lshlrev_b32 v22, 1, v39
    v_xor_b32 v22, v22, v2
    v_lshlrev_b32 v22, 4, v22
    v_and_b32 v2, 15, v42
    v_lshl_add_u32 v22, v2, 8, v22
    v_lshrrev_b32 v2, 4, v42
    v_lshl_add_u32 v22, v2, 14, v22
    v_xor_b32 v23, 16, v22
    v_lshlrev_b32 v48, 16, v240
    v_and_b32 v49, s92, v240
    v_lshlrev_b32 v50, 16, v241
    v_and_b32 v51, s92, v241
    v_lshlrev_b32 v52, 16, v242
    v_and_b32 v53, s92, v242
    v_lshlrev_b32 v54, 16, v243
    v_and_b32 v55, s92, v243
    v_mul_f32 v232, v232, v233
    v_lshlrev_b32 v96, 16, v224
    v_and_b32 v97, s92, v224
    v_lshlrev_b32 v98, 16, v225
    v_and_b32 v99, s92, v225
    v_lshlrev_b32 v100, 16, v226
    v_and_b32 v101, s92, v226
    v_lshlrev_b32 v102, 16, v227
    v_and_b32 v103, s92, v227
    v_fma_f32 v128, v96, v233, -v232
    v_add_f32 v80, v96, v48
    v_fma_f32 v129, v97, v233, -v232
    v_add_f32 v81, v97, v49
    v_fma_f32 v130, v98, v233, -v232
    v_add_f32 v82, v98, v50
    v_fma_f32 v131, v99, v233, -v232
    v_add_f32 v83, v99, v51
    v_fma_f32 v132, v100, v233, -v232
    v_add_f32 v84, v100, v52
    v_fma_f32 v133, v101, v233, -v232
    v_add_f32 v85, v101, v53
    v_fma_f32 v134, v102, v233, -v232
    v_add_f32 v86, v102, v54
    v_fma_f32 v135, v103, v233, -v232
    v_add_f32 v87, v103, v55
    v_mul_f32 v236, v236, v237
    v_lshlrev_b32 v96, 16, v228
    v_and_b32 v97, s92, v228
    v_lshlrev_b32 v98, 16, v229
    v_and_b32 v99, s92, v229
    v_lshlrev_b32 v100, 16, v230
    v_and_b32 v101, s92, v230
    v_lshlrev_b32 v102, 16, v231
    v_and_b32 v103, s92, v231
    v_fma_f32 v136, v96, v237, -v236
    v_add_f32 v88, v96, v48
    v_fma_f32 v137, v97, v237, -v236
    v_add_f32 v89, v97, v49
    v_fma_f32 v138, v98, v237, -v236
    v_add_f32 v90, v98, v50
    v_fma_f32 v139, v99, v237, -v236
    v_add_f32 v91, v99, v51
    v_fma_f32 v140, v100, v237, -v236
    v_add_f32 v92, v100, v52
    v_fma_f32 v141, v101, v237, -v236
    v_add_f32 v93, v101, v53
    v_fma_f32 v142, v102, v237, -v236
    v_add_f32 v94, v102, v54
    v_fma_f32 v143, v103, v237, -v236
    v_add_f32 v95, v103, v55
    s_waitcnt vmcnt(0)
    ds_write_b32 v60, v62 offset:336
    s_cmp_lg_u32 s13, 0
    s_cbranch_scc1 L_epx
    s_mov_b32 s100, 400000
L_lw_19:
    ds_read_b32 v2, v61 offset:336
    s_waitcnt lgkmcnt(0)
    v_cmp_ne_u32 vcc, s96, v2
    s_cbranch_vccz L_lwd_20
    s_sub_u32 s100, s100, 1
    s_cbranch_scc1 L_lwd_20
    s_sleep 1
    s_branch L_lw_19
L_lwd_20:
    s_mov_b64 exec, 0xff
    buffer_store_dword v62, v36, s[44:47], s22 offen sc1
    s_mov_b64 exec, -1
    s_cmp_lg_u32 s2, 248
    s_cbranch_scc1 L_epx
    v_lshlrev_b32 v2, 2, v1
    s_mov_b32 s100, 40000
L_ep:
    s_mov_b32 s11, 4096
    buffer_load_dword v16, v2, s[44:47], s11 offen sc1
    s_mov_b32 s11, 4352
    buffer_load_dword v17, v2, s[44:47], s11 offen sc1
    s_mov_b32 s11, 4608
    buffer_load_dword v18, v2, s[44:47], s11 offen sc1
    s_mov_b32 s11, 4864
    buffer_load_dword v19, v2, s[44:47], s11 offen sc1
    s_waitcnt vmcnt(0)
    v_cmp_ne_u32 vcc, s96, v16
    v_cmp_ne_u32 s[24:25], s96, v17
    s_nop 0
    s_or_b64 vcc, vcc, s[24:25]
    v_cmp_ne_u32 s[24:25], s96, v18
    s_nop 0
    s_or_b64 vcc, vcc, s[24:25]
    v_cmp_ne_u32 s[24:25], s96, v19
    s_nop 0
    s_or_b64 vcc, vcc, s[24:25]
    s_cbranch_scc0 L_epd
    s_sub_u32 s100, s100, 1
    s_cbranch_scc1 L_epd
    s_sleep 8
    s_branch L_ep
L_epd:
    s_mov_b32 s11, 0
    s_mov_b64 exec, 1
    buffer_store_dwordx2 v[62:63], off, s[44:47], s11 sc1
    s_mov_b64 exec, -1
L_epx:
    s_cmp_lg_u32 s13, 1
    s_cbranch_scc1 L_c_fzw
    s_mov_b32 s100, 400000
L_lw_21:
    ds_read_b32 v2, v61 offset:336
    s_waitcnt lgkmcnt(0)
    v_cmp_ne_u32 vcc, s96, v2
    s_cbranch_vccz L_lwd_22
    s_sub_u32 s100, s100, 1
    s_cbranch_scc1 L_lwd_22
    s_sleep 1
    s_branch L_lw_21
L_lwd_22:
    s_mov_b32 s100, 40000
    s_mov_b32 s98, s96
    s_mov_b32 s99, s96
    s_branch L_sp_23
L_spr_25:
    s_sub_u32 s100, s100, 1
    s_cbranch_scc1 L_spd_24
L_sp_23:
    s_buffer_load_dwordx16 s[60:75], s[44:47], s94 glc
    s_buffer_load_dwordx16 s[76:91], s[44:47], s95 glc
L_spw_26:
    s_waitcnt lgkmcnt(0)
    s_cmp_eq_u64 s[60:61], s[98:99]
    s_cbranch_scc0 L_spr_25
    s_cmp_eq_u64 s[62:63], s[98:99]
    s_cbranch_scc0 L_spr_25
    s_cmp_eq_u64 s[64:65], s[98:99]
    s_cbranch_scc0 L_spr_25
    s_cmp_eq_u64 s[66:67], s[98:99]
    s_cbranch_scc0 L_spr_25
    s_cmp_eq_u64 s[68:69], s[98:99]
    s_cbranch_scc0 L_spr_25
    s_cmp_eq_u64 s[70:71], s[98:99]
    s_cbranch_scc0 L_spr_25
    s_cmp_eq_u64 s[72:73], s[98:99]
    s_cbranch_scc0 L_spr_25
    s_cmp_eq_u64 s[74:75], s[98:99]
    s_cbranch_scc0 L_spr_25
    s_cmp_eq_u64 s[76:77], s[98:99]
    s_cbranch_scc0 L_spr_25
    s_cmp_eq_u64 s[78:79], s[98:99]
    s_cbranch_scc0 L_spr_25
    s_cmp_eq_u64 s[80:81], s[98:99]
    s_cbranch_scc0 L_spr_25
    s_cmp_eq_u64 s[82:83], s[98:99]
    s_cbranch_scc0 L_spr_25
    s_cmp_eq_u64 s[84:85], s[98:99]
    s_cbranch_scc0 L_spr_25
    s_cmp_eq_u64 s[86:87], s[98:99]
    s_cbranch_scc0 L_spr_25
    s_cmp_eq_u64 s[88:89], s[98:99]
    s_cbranch_scc0 L_spr_25
    s_cmp_eq_u64 s[90:91], s[98:99]
    s_cbranch_scc0 L_spr_25
L_spd_24:
    s_mov_b32 m0, 135712
    s_add_u32 s11, s19, 0
    buffer_load_dwordx4 v35, s[44:47], s11 offen sc1 lds
    s_mov_b32 m0, 136736
    s_add_u32 s11, s19, 32768
    buffer_load_dwordx4 v35, s[44:47], s11 offen sc1 lds
    s_mov_b32 m0, 131072
    s_add_u32 s11, s19, 65536
    buffer_load_dwordx4 v35, s[44:47], s11 offen sc1 lds
    s_mov_b32 m0, 132096
    s_add_u32 s11, s19, 98304
    buffer_load_dwordx4 v35, s[44:47], s11 offen sc1 lds
    s_mov_b32 m0, 144992
    s_add_u32 s11, s19, 131072
    buffer_load_dwordx4 v35, s[44:47], s11 offen sc1 lds
    s_mov_b32 m0, 146016
    s_add_u32 s11, s19, 163840
    buffer_load_dwordx4 v35, s[44:47], s11 offen sc1 lds
    s_mov_b32 m0, 140352
    s_add_u32 s11, s19, 196608
    buffer_load_dwordx4 v35, s[44:47], s11 offen sc1 lds
    s_mov_b32 m0, 141376
    s_add_u32 s11, s19, 229376
    buffer_load_dwordx4 v35, s[44:47], s11 offen sc1 lds
    s_waitcnt vmcnt(0)
    ds_write_b32 v60, v62 offset:352
L_c_fzw:
    s_mov_b32 s100, 400000
L_lw_27:
    ds_read_b32 v2, v41 offset:352
    s_waitcnt lgkmcnt(0)
    v_cmp_ne_u32 vcc, s96, v2
    s_cbranch_vccz L_lwd_28
    s_sub_u32 s100, s100, 1
    s_cbranch_scc1 L_lwd_28
    s_sleep 1
    s_branch L_lw_27
L_lwd_28:
    ds_read_b64_tr_b16 v[72:73], v37 offset:0
    ds_read_b64_tr_b16 v[74:75], v37 offset:32
    ds_read_b64_tr_b16 v[76:77], v37 offset:64
    ds_read_b64_tr_b16 v[78:79], v37 offset:96
    s_waitcnt lgkmcnt(0)
    ds_write_b64 v38, v[72:73] offset:2048
    ds_write_b64 v38, v[74:75] offset:3072
    ds_write_b64 v38, v[76:77] offset:2560
    ds_write_b64 v38, v[78:79] offset:3584
    ds_write_b32 v60, v62 offset:176
    s_mov_b32 s100, 400000
L_lw_29:
    ds_read_b32 v2, v61 offset:176
    s_waitcnt lgkmcnt(0)
    v_cmp_ne_u32 vcc, s96, v2
    s_cbranch_vccz L_lwd_30
    s_sub_u32 s100, s100, 1
    s_cbranch_scc1 L_lwd_30
    s_sleep 1
    s_branch L_lw_29
L_lwd_30:
    ds_read_b128 v[64:67], v34
    ds_read_b128 v[68:71], v34 offset:1024
    s_waitcnt lgkmcnt(0)
    v_lshlrev_b32 v96, 16, v64
    v_and_b32 v97, s92, v64
    v_fmac_f32 v80, v128, v96
    v_fmac_f32 v81, v129, v97
    v_lshlrev_b32 v96, 16, v65
    v_and_b32 v97, s92, v65
    v_fmac_f32 v82, v130, v96
    v_fmac_f32 v83, v131, v97
    v_lshlrev_b32 v96, 16, v66
    v_and_b32 v97, s92, v66
    v_fmac_f32 v84, v132, v96
    v_fmac_f32 v85, v133, v97
    v_lshlrev_b32 v96, 16, v67
    v_and_b32 v97, s92, v67
    v_fmac_f32 v86, v134, v96
    v_fmac_f32 v87, v135, v97
    v_lshlrev_b32 v96, 16, v68
    v_and_b32 v97, s92, v68
    v_fmac_f32 v88, v136, v96
    v_fmac_f32 v89, v137, v97
    v_lshlrev_b32 v96, 16, v69
    v_and_b32 v97, s92, v69
    v_fmac_f32 v90, v138, v96
    v_fmac_f32 v91, v139, v97
    v_lshlrev_b32 v96, 16, v70
    v_and_b32 v97, s92, v70
    v_fmac_f32 v92, v140, v96
    v_fmac_f32 v93, v141, v97
    v_lshlrev_b32 v96, 16, v71
    v_and_b32 v97, s92, v71
    v_fmac_f32 v94, v142, v96
    v_fmac_f32 v95, v143, v97
    s_barrier
    ds_read_b128 v[160:163], v22 offset:0
    ds_read_b128 v[164:167], v23 offset:0
    ds_read_b128 v[168:171], v22 offset:4096
    ds_read_b128 v[172:175], v23 offset:4096
    ds_read_b128 v[176:179], v22 offset:8192
    ds_read_b128 v[180:183], v23 offset:8192
    ds_read_b128 v[184:187], v22 offset:12288
    ds_read_b128 v[188:191], v23 offset:12288
    ds_read_b128 v[192:195], v22 offset:32768
    ds_read_b128 v[196:199], v23 offset:32768
    ds_read_b128 v[200:203], v22 offset:36864
    ds_read_b128 v[204:207], v23 offset:36864
    ds_read_b128 v[208:211], v22 offset:40960
    ds_read_b128 v[212:215], v23 offset:40960
    ds_read_b128 v[216:219], v22 offset:45056
    ds_read_b128 v[220:223], v23 offset:45056
    s_waitcnt lgkmcnt(14)
    v_pk_add_f32 v[80:81], v[80:81], v[160:161]
    v_pk_add_f32 v[82:83], v[82:83], v[162:163]
    v_pk_add_f32 v[84:85], v[84:85], v[164:165]
    v_pk_add_f32 v[86:87], v[86:87], v[166:167]
    s_waitcnt lgkmcnt(12)
    v_pk_add_f32 v[80:81], v[80:81], v[168:169]
    v_pk_add_f32 v[82:83], v[82:83], v[170:171]
    v_pk_add_f32 v[84:85], v[84:85], v[172:173]
    v_pk_add_f32 v[86:87], v[86:87], v[174:175]
    s_waitcnt lgkmcnt(10)
    v_pk_add_f32 v[80:81], v[80:81], v[176:177]
    v_pk_add_f32 v[82:83], v[82:83], v[178:179]
    v_pk_add_f32 v[84:85], v[84:85], v[180:181]
    v_pk_add_f32 v[86:87], v[86:87], v[182:183]
    s_waitcnt lgkmcnt(8)
    v_pk_add_f32 v[80:81], v[80:81], v[184:185]
    v_pk_add_f32 v[82:83], v[82:83], v[186:187]
    v_pk_add_f32 v[84:85], v[84:85], v[188:189]
    v_pk_add_f32 v[86:87], v[86:87], v[190:191]
    v_cvt_pk_bf16_f32 v64, v80, v81
    v_cvt_pk_bf16_f32 v65, v82, v83
    v_cvt_pk_bf16_f32 v66, v84, v85
    v_cvt_pk_bf16_f32 v67, v86, v87
    buffer_store_dwordx4 v[64:67], v43, s[48:51], s30 offen nt
    s_waitcnt lgkmcnt(6)
    v_pk_add_f32 v[88:89], v[88:89], v[192:193]
    v_pk_add_f32 v[90:91], v[90:91], v[194:195]
    v_pk_add_f32 v[92:93], v[92:93], v[196:197]
    v_pk_add_f32 v[94:95], v[94:95], v[198:199]
    s_waitcnt lgkmcnt(4)
    v_pk_add_f32 v[88:89], v[88:89], v[200:201]
    v_pk_add_f32 v[90:91], v[90:91], v[202:203]
    v_pk_add_f32 v[92:93], v[92:93], v[204:205]
    v_pk_add_f32 v[94:95], v[94:95], v[206:207]
    s_waitcnt lgkmcnt(2)
    v_pk_add_f32 v[88:89], v[88:89], v[208:209]
    v_pk_add_f32 v[90:91], v[90:91], v[210:211]
    v_pk_add_f32 v[92:93], v[92:93], v[212:213]
    v_pk_add_f32 v[94:95], v[94:95], v[214:215]
    s_waitcnt lgkmcnt(0)
    v_pk_add_f32 v[88:89], v[88:89], v[216:217]
    v_pk_add_f32 v[90:91], v[90:91], v[218:219]
    v_pk_add_f32 v[92:93], v[92:93], v[220:221]
    v_pk_add_f32 v[94:95], v[94:95], v[222:223]
    v_cvt_pk_bf16_f32 v68, v88, v89
    v_cvt_pk_bf16_f32 v69, v90, v91
    v_cvt_pk_bf16_f32 v70, v92, v93
    v_cvt_pk_bf16_f32 v71, v94, v95
    buffer_store_dwordx4 v[68:71], v43, s[48:51], s37 offen nt
L_fin:
L_end:
    s_endpgm
L_G2:
    s_mov_b32 s46, 12255232
    s_mov_b32 s47, 0x20000
    s_mov_b64 s[44:45], s[42:43]
    s_mov_b32 s54, 1835008
    s_mov_b32 s55, 0x20000
    s_mov_b64 s[52:53], s[34:35]
    s_mov_b32 s50, 2097152
    s_mov_b32 s51, 0x20000
    s_mov_b64 s[48:49], s[38:39]
    s_mov_b32 s74, 2097152
    s_mov_b32 s75, 0x20000
    s_mov_b64 s[72:73], s[24:25]
    s_mov_b32 s86, 3584
    s_mov_b32 s87, 0x20000
    s_mov_b64 s[84:85], s[32:33]
    s_lshr_b32 s11, s5, 2
    s_lshr_b32 s14, s4, 1
    s_lshl_b32 s8, s14, 3
    s_add_u32 s8, s8, s11
    s_and_b32 s11, s5, 3
    s_and_b32 s14, s4, 1
    s_lshl_b32 s9, s14, 2
    s_add_u32 s9, s9, s11
    s_mul_i32 s11, s11, 0
    s_add_u32 s11, s11, 1
    s_lshr_b32 s12, s11, 1
    s_mov_b32 s92, 0xffff0000
    v_and_b32 v3, 15, v1
    v_lshrrev_b32 v7, 2, v1
    v_lshlrev_b32 v8, 4, v1
    v_lshl_add_u32 v11, v10, 2, v6
    v_lshlrev_b32 v11, 10, v11
    v_and_b32 v2, 1, v4
    v_lshl_add_u32 v11, v2, 6, v11
    v_lshl_add_u32 v11, v5, 4, v11
    s_lshl_b32 s11, s9, 7
    v_add_u32 v11, s11, v11
    v_lshlrev_b32 v21, 6, v6
    v_lshl_add_u32 v21, v2, 5, v21
    v_lshl_add_u32 v21, v5, 3, v21
    s_lshl_b32 s11, s13, 2
    s_add_u32 s11, s11, 158080
    v_mov_b32 v60, s11
    v_lshlrev_b32 v61, 2, v5
    v_add_u32 v61, 158080, v61
    buffer_load_dword v176, v201, s[60:63], 0 offen offset:0 nt
    buffer_load_dword v177, v201, s[60:63], 0 offen offset:1024 nt
    buffer_load_dword v178, v201, s[60:63], 0 offen offset:2048 nt
    buffer_load_dword v179, v200, s[60:63], 0 offen offset:0 nt
    buffer_load_dword v180, v200, s[60:63], 0 offen offset:1024 nt
    buffer_load_dword v181, v200, s[60:63], 0 offen offset:2048 nt
    buffer_load_dword v182, v200, s[60:63], 0 offen offset:3072 nt
    buffer_load_dword v183, v202, s[60:63], 0 offen offset:0 nt
    buffer_load_dword v184, v202, s[60:63], 0 offen offset:1024 nt
    buffer_load_dword v185, v202, s[60:63], 0 offen offset:2048 nt
    buffer_load_dword v186, v202, s[60:63], 0 offen offset:3072 nt
    buffer_load_dword v187, v200, s[64:67], 0 offen offset:0 nt
    buffer_load_dword v188, v200, s[64:67], 0 offen offset:1024 nt
    buffer_load_dword v189, v200, s[64:67], 0 offen offset:2048 nt
    buffer_load_dword v190, v200, s[64:67], 0 offen offset:3072 nt
    buffer_load_dword v191, v202, s[64:67], 0 offen offset:0 nt
    buffer_load_dword v192, v202, s[64:67], 0 offen offset:1024 nt
    buffer_load_dword v193, v202, s[64:67], 0 offen offset:2048 nt
    buffer_load_dword v194, v202, s[64:67], 0 offen offset:3072 nt
    buffer_load_dwordx4 v[196:199], v207, s[68:71], 0 offen
    s_lshl_b32 s14, s13, 1
    s_sub_u32 s14, 7, s14
    v_sub_u32 v203, s14, v10
    v_and_b32 v2, 7, v9
    v_xor_b32 v203, v203, v2
    v_lshlrev_b32 v203, 4, v203
    v_lshl_add_u32 v203, v9, 8, v203
    v_add_u32 v203, 131072, v203
    s_mov_b32 s16, 0x05040100
    s_mov_b32 s17, 0x07060302
    v_and_b32 v2, 7, v9
    v_lshrrev_b32 v206, 3, v1
    v_xor_b32 v204, v4, v2
    v_lshlrev_b32 v204, 4, v204
    v_lshl_add_u32 v204, v206, 7, v204
    s_lshl_b32 s14, s13, 11
    s_add_u32 s14, s14, 131072
    v_add_u32 v204, s14, v204
    v_xor_b32 v205, 64, v204
    v_mul_u32_u24 v206, 4224, v206
    v_lshl_add_u32 v206, v2, 4, v206
    s_lshl_b32 s32, s94, 2
    s_add_u32 s32, s32, s13
    s_lshl_b32 s34, s2, 2
    s_add_u32 s34, s34, 4096
    s_mul_i32 s32, s32, 67584
    s_lshl_b32 s11, s95, 7
    s_sub_u32 s32, s32, s11
    s_add_u32 s32, s32, 266112
    s_add_u32 s33, s32, 33792
    v_bfe_u32 v22, v1, 1, 3
    v_xor_b32 v22, v22, v10
    v_lshlrev_b32 v22, 4, v22
    v_lshl_add_u32 v22, v9, 7, v22
    s_lshr_b32 s14, s13, 1
    s_lshl_b32 s14, s14, 13
    v_add_u32 v232, s14, v22
    v_xor_b32 v233, 32, v232
    v_xor_b32 v234, 64, v232
    v_xor_b32 v235, 96, v232
    v_add_u32 v236, 0x10000, v232
    v_add_u32 v237, 0x10000, v233
    v_add_u32 v238, 0x10000, v234
    v_add_u32 v239, 0x10000, v235
    v_lshl_add_u32 v28, v10, 11, v21
    s_and_b32 s14, s13, 1
    s_lshl_b32 s14, s14, 1
    s_lshr_b32 s11, s13, 1
    s_add_u32 s29, s14, s11
    s_lshl_b32 s14, s29, 8
    s_add_u32 s14, s14, 16384
    v_add_u32 v240, s14, v28
    v_add_u32 v241, 0x10000, v240
    v_xor_b32 v242, 256, v240
    v_xor_b32 v243, 256, v241
    s_lshl_b32 s11, s7, 8
    s_lshl_b32 s14, s29, 6
    s_add_u32 s11, s11, s14
    v_lshlrev_b32 v2, 1, v9
    buffer_load_ushort v59, v2, s[84:87], s11 offen
    v_xor_b32 v2, v4, v1
    v_and_b32 v2, 1, v2
    v_cmp_eq_u32 vcc, 0, v2
    v_mov_b32 v2, 0x3f803f80
    s_nop 0
    v_cndmask_b32 v244, 0, v2, vcc
    v_cndmask_b32 v245, 0, v2, vcc
    v_cndmask_b32 v246, 0, v2, vcc
    v_cndmask_b32 v247, 0, v2, vcc
    s_lshl_b32 s11, s29, 9
    s_add_u32 s11, s11, 158592
    v_add_u32 v23, s11, v15
    s_xor_b32 s14, s29, 1
    s_lshl_b32 s14, s14, 9
    s_add_u32 s14, s14, 158592
    v_add_u32 v24, s14, v15
    v_xor_b32 v25, 8, v60
    s_lshl_b32 s22, s6, 1
    s_lshr_b32 s11, s13, 1
    s_add_u32 s22, s22, s11
    s_lshl_b32 s23, s22, 12
    s_add_u32 s23, s23, 86016
    v_lshlrev_b32 v26, 6, v9
    v_lshlrev_b32 v22, 31, v10
    v_or_b32 v22, v22, v26
    s_lshr_b32 s11, s13, 1
    s_lshl_b32 s11, s11, 12
    s_add_u32 s11, s11, 139264
    v_add_u32 v27, s11, v26
    v_add_u32 v57, 2048, v27
    v_mov_b32 v2, 149632
    v_cmp_gt_u32 vcc, 32, v1
    s_nop 1
    v_cndmask_b32 v56, v2, v27, vcc
    v_cndmask_b32 v57, v2, v57, vcc
    s_lshl_b32 s24, s7, 1
    s_and_b32 s11, s13, 1
    s_add_u32 s24, s24, s11
    s_mul_i32 s26, s22, 28
    s_add_u32 s26, s26, s24
    s_lshl_b32 s26, s26, 13
    s_add_u32 s26, s26, 4521984
    s_lshr_b32 s11, s13, 1
    s_lshl_b32 s11, s11, 12
    s_add_u32 s26, s26, s11
    s_xor_b32 s27, s26, 4096
    s_mul_i32 s11, s24, 37
    s_lshr_b32 s11, s11, 8
    s_mul_i32 s14, s11, 25
    s_add_u32 s14, s14, s24
    s_lshl_b32 s28, s22, 7
    s_add_u32 s28, s28, s14
    s_lshl_b32 s28, s28, 2
    s_add_u32 s28, s28, 36864
    s_waitcnt lgkmcnt(0)
    s_mul_i32 s96, s96, 1664525
    s_add_u32 s96, s96, 1013904223
    s_cmp_eq_u32 s96, 0
    s_cselect_b32 s96, 1013904223, s96
    s_mul_i32 s97, s97, 22695477
    s_add_u32 s97, s97, 0x9e3779b9
    v_mov_b32 v62, s96
    v_mov_b32 v63, s97
    s_waitcnt vmcnt(21)
    s_mov_b32 s11, 0x3f803f80
    v_mov_b32 v216, 0
    v_mov_b32 v217, 0
    v_mov_b32 v218, 0
    v_mov_b32 v219, 0
    v_dot2c_f32_bf16 v216, s11, v208
    v_dot2c_f32_bf16 v218, v208, v208
    v_dot2c_f32_bf16 v217, s11, v209
    v_dot2c_f32_bf16 v219, v209, v209
    v_dot2c_f32_bf16 v216, s11, v210
    v_dot2c_f32_bf16 v218, v210, v210
    v_dot2c_f32_bf16 v217, s11, v211
    v_dot2c_f32_bf16 v219, v211, v211
    v_dot2c_f32_bf16 v216, s11, v212
    v_dot2c_f32_bf16 v218, v212, v212
    v_dot2c_f32_bf16 v217, s11, v213
    v_dot2c_f32_bf16 v219, v213, v213
    v_dot2c_f32_bf16 v216, s11, v214
    v_dot2c_f32_bf16 v218, v214, v214
    v_dot2c_f32_bf16 v217, s11, v215
    v_dot2c_f32_bf16 v219, v215, v215
    s_nop 1
    v_add_f32 v216, v216, v217
    v_add_f32 v218, v218, v219
    v_mov_b32 v217, v216
    v_mov_b32 v219, v218
    s_nop 0
    v_permlane16_swap_b32 v216, v217
    v_permlane16_swap_b32 v218, v219
    v_add_f32 v216, v216, v217
    v_add_f32 v218, v218, v219
    s_nop 0
    v_add_f32_dpp v216, v216, v216 row_ror:8 row_mask:0xf bank_mask:0xf
    v_add_f32_dpp v218, v218, v218 row_ror:8 row_mask:0xf bank_mask:0xf
    s_nop 0
    v_add_f32_dpp v216, v216, v216 row_ror:4 row_mask:0xf bank_mask:0xf
    v_add_f32_dpp v218, v218, v218 row_ror:4 row_mask:0xf bank_mask:0xf
    s_nop 0
    v_add_f32_dpp v216, v216, v216 row_ror:2 row_mask:0xf bank_mask:0xf
    v_add_f32_dpp v218, v218, v218 row_ror:2 row_mask:0xf bank_mask:0xf
    s_nop 0
    v_add_f32_dpp v216, v216, v216 row_ror:1 row_mask:0xf bank_mask:0xf
    v_add_f32_dpp v218, v218, v218 row_ror:1 row_mask:0xf bank_mask:0xf
    v_mul_f32 v208, 0x3b000000, v216
    v_mul_f32 v218, 0x3b000000, v218
    v_fma_f32 v218, -v208, v208, v218
    v_max_f32 v218, 0, v218
    v_add_f32 v217, 0x3727c5ac, v218
    v_rsq_f32 v209, v217
    s_nop 0
    v_mul_f32 v218, v218, v209
    v_mul_f32 v218, v218, v209
    v_add_f32 v218, 0x3727c5ac, v218
    v_rsq_f32 v218, v218
    s_nop 0
    v_mul_f32 v210, v209, v218
    v_mov_b32 v211, s96
    v_rcp_f32 v219, v210
    v_cvt_pk_bf16_f32 v212, -v208, -v208
    v_and_b32 v220, s92, v212
    v_sub_f32 v220, -v208, v220
    v_cvt_pk_bf16_f32 v213, v220, v219
    v_and_b32 v221, s92, v213
    v_sub_f32 v221, v219, v221
    v_cvt_pk_bf16_f32 v222, v221, v221
    v_and_b32 v222, s92, v222
    v_sub_f32 v222, v221, v222
    v_cvt_pk_bf16_f32 v214, v221, v222
    v_mov_b32 v215, s96
    v_mul_f32 v216, 0xc0135761, v210
    v_mov_b32 v217, s96
    v_mul_f32 v223, v210, v210
    v_mul_f32 v218, 0x3d372713, v216
    v_mul_f32 v218, v218, v223
    v_cmp_eq_u32 vcc, 0, v5
    v_cmp_eq_u32 s[14:15], 1, v5
    s_nop 0
    v_cndmask_b32 v208, v208, v212, vcc
    v_cndmask_b32 v208, v208, v216, s[14:15]
    v_cndmask_b32 v209, v209, v213, vcc
    v_cndmask_b32 v209, v209, v217, s[14:15]
    v_cndmask_b32 v210, v210, v214, vcc
    v_cndmask_b32 v210, v210, v218, s[14:15]
    v_cndmask_b32 v211, v211, v215, vcc
    v_cndmask_b32 v211, v211, v219, s[14:15]
    v_lshlrev_b32 v224, 6, v10
    v_lshl_add_u32 v224, v5, 4, v224
    s_lshl_b32 s11, s93, 6
    s_add_u32 s11, s11, 86016
    s_mov_b32 exec_lo, 15
    s_mov_b32 exec_hi, 15
    buffer_store_dwordx4 v[208:211], v224, s[44:47], s11 offen sc1
    s_mov_b64 exec, -1
    s_cmp_ge_u32 s5, 28
    s_cbranch_scc1 L_g_helper
    s_barrier
    ds_read_b128 v[128:131], v232 offset:0
    ds_read_b64_tr_b16 v[136:137], v240 offset:0
    ds_read_b64_tr_b16 v[138:139], v240 offset:1024
    ds_read_b128 v[132:135], v232 offset:4096
    ds_read_b64_tr_b16 v[140:141], v242 offset:0
    ds_read_b64_tr_b16 v[142:143], v242 offset:1024
    ds_read_b128 v[144:147], v233 offset:0
    ds_read_b64_tr_b16 v[152:153], v240 offset:4096
    ds_read_b64_tr_b16 v[154:155], v240 offset:5120
    ds_read_b128 v[148:151], v233 offset:4096
    ds_read_b64_tr_b16 v[156:157], v242 offset:4096
    ds_read_b64_tr_b16 v[158:159], v242 offset:5120
    s_waitcnt lgkmcnt(6)
    v_mfma_f32_16x16x32_bf16 v[248:251], v[244:247], v[136:139], 0
    v_mfma_f32_32x32x16_bf16 v[64:79], v[136:139], v[128:131], 0
    ds_read_b128 v[160:163], v234 offset:0
    ds_read_b64_tr_b16 v[168:169], v240 offset:8192
    ds_read_b64_tr_b16 v[170:171], v240 offset:9216
    v_mfma_f32_32x32x16_bf16 v[80:95], v[136:139], v[132:135], 0
    ds_read_b128 v[164:167], v234 offset:4096
    ds_read_b64_tr_b16 v[172:173], v242 offset:8192
    ds_read_b64_tr_b16 v[174:175], v242 offset:9216
    v_mfma_f32_32x32x16_bf16 v[96:111], v[140:143], v[128:131], 0
    v_mfma_f32_32x32x16_bf16 v[112:127], v[140:143], v[132:135], 0
    s_waitcnt lgkmcnt(6)
    v_mfma_f32_16x16x32_bf16 v[248:251], v[244:247], v[152:155], v[248:251]
    v_mfma_f32_32x32x16_bf16 v[64:79], v[152:155], v[144:147], v[64:79]
    ds_read_b128 v[128:131], v235 offset:0
    ds_read_b64_tr_b16 v[136:137], v240 offset:12288
    ds_read_b64_tr_b16 v[138:139], v240 offset:13312
    v_mfma_f32_32x32x16_bf16 v[80:95], v[152:155], v[148:151], v[80:95]
    ds_read_b128 v[132:135], v235 offset:4096
    ds_read_b64_tr_b16 v[140:141], v242 offset:12288
    ds_read_b64_tr_b16 v[142:143], v242 offset:13312
    v_mfma_f32_32x32x16_bf16 v[96:111], v[156:159], v[144:147], v[96:111]
    v_mfma_f32_32x32x16_bf16 v[112:127], v[156:159], v[148:151], v[112:127]
    s_waitcnt lgkmcnt(6)
    v_mfma_f32_16x16x32_bf16 v[248:251], v[244:247], v[168:171], v[248:251]
    v_mfma_f32_32x32x16_bf16 v[64:79], v[168:171], v[160:163], v[64:79]
    v_mfma_f32_32x32x16_bf16 v[80:95], v[168:171], v[164:167], v[80:95]
    v_mfma_f32_32x32x16_bf16 v[96:111], v[172:175], v[160:163], v[96:111]
    v_mfma_f32_32x32x16_bf16 v[112:127], v[172:175], v[164:167], v[112:127]
    s_waitcnt vmcnt(1)
    v_perm_b32 v28, v176, v177, s16
    v_perm_b32 v29, v177, v178, s16
    v_perm_b32 v30, v178, v179, s16
    v_perm_b32 v31, v179, v180, s16
    v_perm_b32 v32, v180, v181, s16
    v_perm_b32 v33, v181, v182, s16
    v_perm_b32 v34, v182, v183, s16
    v_perm_b32 v35, v183, v184, s16
    v_perm_b32 v36, v184, v185, s16
    v_perm_b32 v37, v185, v186, s16
    v_dot2_f32_bf16 v38, v30, v196, 0
    v_dot2_f32_bf16 v39, v31, v196, 0
    v_dot2_f32_bf16 v40, v32, v196, 0
    v_dot2_f32_bf16 v41, v33, v196, 0
    v_dot2_f32_bf16 v42, v34, v196, 0
    v_dot2_f32_bf16 v43, v35, v196, 0
    v_dot2_f32_bf16 v44, v36, v196, 0
    v_dot2_f32_bf16 v45, v37, v196, 0
    v_dot2_f32_bf16 v38, v28, v197, v38
    v_dot2_f32_bf16 v39, v29, v197, v39
    v_dot2_f32_bf16 v40, v30, v197, v40
    v_dot2_f32_bf16 v41, v31, v197, v41
    v_dot2_f32_bf16 v42, v32, v197, v42
    v_dot2_f32_bf16 v43, v33, v197, v43
    v_dot2_f32_bf16 v44, v34, v197, v44
    v_dot2_f32_bf16 v45, v35, v197, v45
    v_lshlrev_b32 v46, 16, v187
    v_lshlrev_b32 v47, 16, v188
    v_lshlrev_b32 v48, 16, v189
    v_lshlrev_b32 v49, 16, v190
    v_lshlrev_b32 v50, 16, v191
    v_lshlrev_b32 v51, 16, v192
    v_lshlrev_b32 v52, 16, v193
    v_lshlrev_b32 v53, 16, v194
    v_pk_mul_f32 v[38:39], v[38:39], v[46:47]
    v_pk_mul_f32 v[40:41], v[40:41], v[48:49]
    v_pk_mul_f32 v[42:43], v[42:43], v[50:51]
    v_pk_mul_f32 v[44:45], v[44:45], v[52:53]
    v_cvt_pk_bf16_f32 v224, v45, v44
    v_cvt_pk_bf16_f32 v225, v43, v42
    v_cvt_pk_bf16_f32 v226, v41, v40
    v_cvt_pk_bf16_f32 v227, v39, v38
    ds_write_b128 v203, v[224:227] offset:0
    v_perm_b32 v28, v176, v177, s17
    v_perm_b32 v29, v177, v178, s17
    v_perm_b32 v30, v178, v179, s17
    v_perm_b32 v31, v179, v180, s17
    v_perm_b32 v32, v180, v181, s17
    v_perm_b32 v33, v181, v182, s17
    v_perm_b32 v34, v182, v183, s17
    v_perm_b32 v35, v183, v184, s17
    v_perm_b32 v36, v184, v185, s17
    v_perm_b32 v37, v185, v186, s17
    v_dot2_f32_bf16 v38, v30, v198, 0
    v_dot2_f32_bf16 v39, v31, v198, 0
    v_dot2_f32_bf16 v40, v32, v198, 0
    v_dot2_f32_bf16 v41, v33, v198, 0
    v_dot2_f32_bf16 v42, v34, v198, 0
    v_dot2_f32_bf16 v43, v35, v198, 0
    v_dot2_f32_bf16 v44, v36, v198, 0
    v_dot2_f32_bf16 v45, v37, v198, 0
    v_dot2_f32_bf16 v38, v28, v199, v38
    v_dot2_f32_bf16 v39, v29, v199, v39
    v_dot2_f32_bf16 v40, v30, v199, v40
    v_dot2_f32_bf16 v41, v31, v199, v41
    v_dot2_f32_bf16 v42, v32, v199, v42
    v_dot2_f32_bf16 v43, v33, v199, v43
    v_dot2_f32_bf16 v44, v34, v199, v44
    v_dot2_f32_bf16 v45, v35, v199, v45
    v_and_b32 v46, s92, v187
    v_and_b32 v47, s92, v188
    v_and_b32 v48, s92, v189
    v_and_b32 v49, s92, v190
    v_and_b32 v50, s92, v191
    v_and_b32 v51, s92, v192
    v_and_b32 v52, s92, v193
    v_and_b32 v53, s92, v194
    v_pk_mul_f32 v[38:39], v[38:39], v[46:47]
    v_pk_mul_f32 v[40:41], v[40:41], v[48:49]
    v_pk_mul_f32 v[42:43], v[42:43], v[50:51]
    v_pk_mul_f32 v[44:45], v[44:45], v[52:53]
    v_cvt_pk_bf16_f32 v228, v45, v44
    v_cvt_pk_bf16_f32 v229, v43, v42
    v_cvt_pk_bf16_f32 v230, v41, v40
    v_cvt_pk_bf16_f32 v231, v39, v38
    ds_write_b128 v203, v[228:231] offset:128
    s_waitcnt lgkmcnt(0)
    s_barrier
    ds_read_b128 v[176:179], v204
    ds_read_b128 v[180:183], v205 offset:1024
    v_mfma_f32_16x16x32_bf16 v[248:251], v[244:247], v[136:139], v[248:251]
    v_mfma_f32_32x32x16_bf16 v[64:79], v[136:139], v[128:131], v[64:79]
    ds_read_b128 v[144:147], v232 offset:32768
    ds_read_b64_tr_b16 v[152:153], v240 offset:32768
    ds_read_b64_tr_b16 v[154:155], v240 offset:33792
    v_mfma_f32_32x32x16_bf16 v[80:95], v[136:139], v[132:135], v[80:95]
    ds_read_b128 v[148:151], v232 offset:36864
    ds_read_b64_tr_b16 v[156:157], v242 offset:32768
    ds_read_b64_tr_b16 v[158:159], v242 offset:33792
    v_mfma_f32_32x32x16_bf16 v[96:111], v[140:143], v[128:131], v[96:111]
    ds_read_b128 v[160:163], v233 offset:32768
    ds_read_b64_tr_b16 v[168:169], v240 offset:36864
    ds_read_b64_tr_b16 v[170:171], v240 offset:37888
    v_mfma_f32_32x32x16_bf16 v[112:127], v[140:143], v[132:135], v[112:127]
    ds_read_b128 v[164:167], v233 offset:36864
    ds_read_b64_tr_b16 v[172:173], v242 offset:36864
    ds_read_b64_tr_b16 v[174:175], v242 offset:37888
    s_waitcnt lgkmcnt(6)
    v_mfma_f32_16x16x32_bf16 v[248:251], v[244:247], v[152:155], v[248:251]
    v_mfma_f32_32x32x16_bf16 v[64:79], v[152:155], v[144:147], v[64:79]
    ds_read_b128 v[128:131], v234 offset:32768
    ds_read_b64_tr_b16 v[136:137], v240 offset:40960
    ds_read_b64_tr_b16 v[138:139], v240 offset:41984
    v_mfma_f32_32x32x16_bf16 v[80:95], v[152:155], v[148:151], v[80:95]
    ds_read_b128 v[132:135], v234 offset:36864
    ds_read_b64_tr_b16 v[140:141], v242 offset:40960
    ds_read_b64_tr_b16 v[142:143], v242 offset:41984
    v_mfma_f32_32x32x16_bf16 v[96:111], v[156:159], v[144:147], v[96:111]
    v_mfma_f32_32x32x16_bf16 v[112:127], v[156:159], v[148:151], v[112:127]
    s_waitcnt lgkmcnt(6)
    v_mfma_f32_16x16x32_bf16 v[248:251], v[244:247], v[168:171], v[248:251]
    v_mfma_f32_32x32x16_bf16 v[64:79], v[168:171], v[160:163], v[64:79]
    ds_read_b128 v[144:147], v235 offset:32768
    ds_read_b64_tr_b16 v[152:153], v240 offset:45056
    ds_read_b64_tr_b16 v[154:155], v240 offset:46080
    v_mfma_f32_32x32x16_bf16 v[80:95], v[168:171], v[164:167], v[80:95]
    ds_read_b128 v[148:151], v235 offset:36864
    ds_read_b64_tr_b16 v[156:157], v242 offset:45056
    ds_read_b64_tr_b16 v[158:159], v242 offset:46080
    v_mfma_f32_32x32x16_bf16 v[96:111], v[172:175], v[160:163], v[96:111]
    v_mfma_f32_32x32x16_bf16 v[112:127], v[172:175], v[164:167], v[112:127]
    buffer_store_dwordx4 v[176:179], v206, s[44:47], s32 offen sc1
    buffer_store_dwordx4 v[180:183], v206, s[44:47], s33 offen sc1
    s_waitcnt lgkmcnt(6)
    v_mfma_f32_16x16x32_bf16 v[248:251], v[244:247], v[136:139], v[248:251]
    v_mfma_f32_32x32x16_bf16 v[64:79], v[136:139], v[128:131], v[64:79]
    v_mfma_f32_32x32x16_bf16 v[80:95], v[136:139], v[132:135], v[80:95]
    v_mfma_f32_32x32x16_bf16 v[96:111], v[140:143], v[128:131], v[96:111]
    v_mfma_f32_32x32x16_bf16 v[112:127], v[140:143], v[132:135], v[112:127]
    s_waitcnt lgkmcnt(0)
    s_barrier
    v_mfma_f32_16x16x32_bf16 v[248:251], v[244:247], v[152:155], v[248:251]
    v_mfma_f32_32x32x16_bf16 v[64:79], v[152:155], v[144:147], v[64:79]
    ds_read_b128 v[160:163], v236 offset:0
    ds_read_b64_tr_b16 v[168:169], v241 offset:0
    ds_read_b64_tr_b16 v[170:171], v241 offset:1024
    v_mfma_f32_32x32x16_bf16 v[80:95], v[152:155], v[148:151], v[80:95]
    ds_read_b128 v[164:167], v236 offset:4096
    ds_read_b64_tr_b16 v[172:173], v243 offset:0
    ds_read_b64_tr_b16 v[174:175], v243 offset:1024
    v_mfma_f32_32x32x16_bf16 v[96:111], v[156:159], v[144:147], v[96:111]
    ds_read_b128 v[128:131], v237 offset:0
    ds_read_b64_tr_b16 v[136:137], v241 offset:4096
    ds_read_b64_tr_b16 v[138:139], v241 offset:5120
    v_mfma_f32_32x32x16_bf16 v[112:127], v[156:159], v[148:151], v[112:127]
    ds_read_b128 v[132:135], v237 offset:4096
    ds_read_b64_tr_b16 v[140:141], v243 offset:4096
    ds_read_b64_tr_b16 v[142:143], v243 offset:5120
    s_waitcnt lgkmcnt(6)
    v_mfma_f32_16x16x32_bf16 v[248:251], v[244:247], v[168:171], v[248:251]
    v_mfma_f32_32x32x16_bf16 v[64:79], v[168:171], v[160:163], v[64:79]
    ds_read_b128 v[144:147], v238 offset:0
    ds_read_b64_tr_b16 v[152:153], v241 offset:8192
    ds_read_b64_tr_b16 v[154:155], v241 offset:9216
    v_mfma_f32_32x32x16_bf16 v[80:95], v[168:171], v[164:167], v[80:95]
    ds_read_b128 v[148:151], v238 offset:4096
    ds_read_b64_tr_b16 v[156:157], v243 offset:8192
    ds_read_b64_tr_b16 v[158:159], v243 offset:9216
    v_mfma_f32_32x32x16_bf16 v[96:111], v[172:175], v[160:163], v[96:111]
    v_mfma_f32_32x32x16_bf16 v[112:127], v[172:175], v[164:167], v[112:127]
    s_waitcnt lgkmcnt(6)
    v_mfma_f32_16x16x32_bf16 v[248:251], v[244:247], v[136:139], v[248:251]
    v_mfma_f32_32x32x16_bf16 v[64:79], v[136:139], v[128:131], v[64:79]
    ds_read_b128 v[160:163], v239 offset:0
    ds_read_b64_tr_b16 v[168:169], v241 offset:12288
    ds_read_b64_tr_b16 v[170:171], v241 offset:13312
    v_mfma_f32_32x32x16_bf16 v[80:95], v[136:139], v[132:135], v[80:95]
    ds_read_b128 v[164:167], v239 offset:4096
    ds_read_b64_tr_b16 v[172:173], v243 offset:12288
    ds_read_b64_tr_b16 v[174:175], v243 offset:13312
    v_mfma_f32_32x32x16_bf16 v[96:111], v[140:143], v[128:131], v[96:111]
    v_mfma_f32_32x32x16_bf16 v[112:127], v[140:143], v[132:135], v[112:127]
    s_waitcnt lgkmcnt(6)
    v_mfma_f32_16x16x32_bf16 v[248:251], v[244:247], v[152:155], v[248:251]
    v_mfma_f32_32x32x16_bf16 v[64:79], v[152:155], v[144:147], v[64:79]
    v_mfma_f32_32x32x16_bf16 v[80:95], v[152:155], v[148:151], v[80:95]
    v_mfma_f32_32x32x16_bf16 v[96:111], v[156:159], v[144:147], v[96:111]
    v_mfma_f32_32x32x16_bf16 v[112:127], v[156:159], v[148:151], v[112:127]
    s_waitcnt lgkmcnt(0)
    s_barrier
    v_mfma_f32_16x16x32_bf16 v[248:251], v[244:247], v[168:171], v[248:251]
    v_mfma_f32_32x32x16_bf16 v[64:79], v[168:171], v[160:163], v[64:79]
    ds_read_b128 v[128:131], v236 offset:32768
    ds_read_b64_tr_b16 v[136:137], v241 offset:32768
    ds_read_b64_tr_b16 v[138:139], v241 offset:33792
    v_mfma_f32_32x32x16_bf16 v[80:95], v[168:171], v[164:167], v[80:95]
    ds_read_b128 v[132:135], v236 offset:36864
    ds_read_b64_tr_b16 v[140:141], v243 offset:32768
    ds_read_b64_tr_b16 v[142:143], v243 offset:33792
    v_mfma_f32_32x32x16_bf16 v[96:111], v[172:175], v[160:163], v[96:111]
    ds_read_b128 v[144:147], v237 offset:32768
    ds_read_b64_tr_b16 v[152:153], v241 offset:36864
    ds_read_b64_tr_b16 v[154:155], v241 offset:37888
    v_mfma_f32_32x32x16_bf16 v[112:127], v[172:175], v[164:167], v[112:127]
    ds_read_b128 v[148:151], v237 offset:36864
    ds_read_b64_tr_b16 v[156:157], v243 offset:36864
    ds_read_b64_tr_b16 v[158:159], v243 offset:37888
    s_waitcnt lgkmcnt(6)
    v_mfma_f32_16x16x32_bf16 v[248:251], v[244:247], v[136:139], v[248:251]
    v_mfma_f32_32x32x16_bf16 v[64:79], v[136:139], v[128:131], v[64:79]
    ds_read_b128 v[160:163], v238 offset:32768
    ds_read_b64_tr_b16 v[168:169], v241 offset:40960
    ds_read_b64_tr_b16 v[170:171], v241 offset:41984
    v_mfma_f32_32x32x16_bf16 v[80:95], v[136:139], v[132:135], v[80:95]
    ds_read_b128 v[164:167], v238 offset:36864
    ds_read_b64_tr_b16 v[172:173], v243 offset:40960
    ds_read_b64_tr_b16 v[174:175], v243 offset:41984
    v_mfma_f32_32x32x16_bf16 v[96:111], v[140:143], v[128:131], v[96:111]
    v_mfma_f32_32x32x16_bf16 v[112:127], v[140:143], v[132:135], v[112:127]
    s_waitcnt lgkmcnt(6)
    v_mfma_f32_16x16x32_bf16 v[248:251], v[244:247], v[152:155], v[248:251]
    v_mfma_f32_32x32x16_bf16 v[64:79], v[152:155], v[144:147], v[64:79]
    ds_read_b128 v[128:131], v239 offset:32768
    ds_read_b64_tr_b16 v[136:137], v241 offset:45056
    ds_read_b64_tr_b16 v[138:139], v241 offset:46080
    v_mfma_f32_32x32x16_bf16 v[80:95], v[152:155], v[148:151], v[80:95]
    ds_read_b128 v[132:135], v239 offset:36864
    ds_read_b64_tr_b16 v[140:141], v243 offset:45056
    ds_read_b64_tr_b16 v[142:143], v243 offset:46080
    v_mfma_f32_32x32x16_bf16 v[96:111], v[156:159], v[144:147], v[96:111]
    v_mfma_f32_32x32x16_bf16 v[112:127], v[156:159], v[148:151], v[112:127]
    s_waitcnt lgkmcnt(6)
    v_mfma_f32_16x16x32_bf16 v[248:251], v[244:247], v[168:171], v[248:251]
    v_mfma_f32_32x32x16_bf16 v[64:79], v[168:171], v[160:163], v[64:79]
    v_mfma_f32_32x32x16_bf16 v[80:95], v[168:171], v[164:167], v[80:95]
    v_mfma_f32_32x32x16_bf16 v[96:111], v[172:175], v[160:163], v[96:111]
    v_mfma_f32_32x32x16_bf16 v[112:127], v[172:175], v[164:167], v[112:127]
    s_waitcnt vmcnt(0)
    s_waitcnt lgkmcnt(0)
    s_barrier
    v_mfma_f32_16x16x32_bf16 v[248:251], v[244:247], v[136:139], v[248:251]
    v_mfma_f32_32x32x16_bf16 v[64:79], v[136:139], v[128:131], v[64:79]
    ds_read_b128 v[144:147], v232 offset:0
    ds_read_b64_tr_b16 v[152:153], v240 offset:0
    ds_read_b64_tr_b16 v[154:155], v240 offset:1024
    v_mfma_f32_32x32x16_bf16 v[80:95], v[136:139], v[132:135], v[80:95]
    ds_read_b128 v[148:151], v232 offset:4096
    ds_read_b64_tr_b16 v[156:157], v242 offset:0
    ds_read_b64_tr_b16 v[158:159], v242 offset:1024
    v_mfma_f32_32x32x16_bf16 v[96:111], v[140:143], v[128:131], v[96:111]
    ds_read_b128 v[160:163], v233 offset:0
    ds_read_b64_tr_b16 v[168:169], v240 offset:4096
    ds_read_b64_tr_b16 v[170:171], v240 offset:5120
    v_mfma_f32_32x32x16_bf16 v[112:127], v[140:143], v[132:135], v[112:127]
    ds_read_b128 v[164:167], v233 offset:4096
    ds_read_b64_tr_b16 v[172:173], v242 offset:4096
    ds_read_b64_tr_b16 v[174:175], v242 offset:5120
    ds_read_b128 v[208:211], v56
    ds_read_b128 v[212:215], v57
    ds_read_b128 v[216:219], v27 offset:16
    ds_read_b128 v[220:223], v27 offset:2064
    s_waitcnt lgkmcnt(10)
    v_mfma_f32_16x16x32_bf16 v[248:251], v[244:247], v[152:155], v[248:251]
    v_mfma_f32_32x32x16_bf16 v[64:79], v[152:155], v[144:147], v[64:79]
    ds_read_b128 v[128:131], v234 offset:0
    ds_read_b64_tr_b16 v[136:137], v240 offset:8192
    ds_read_b64_tr_b16 v[138:139], v240 offset:9216
    v_mfma_f32_32x32x16_bf16 v[80:95], v[152:155], v[148:151], v[80:95]
    ds_read_b128 v[132:135], v234 offset:4096
    ds_read_b64_tr_b16 v[140:141], v242 offset:8192
    ds_read_b64_tr_b16 v[142:143], v242 offset:9216
    v_mfma_f32_32x32x16_bf16 v[96:111], v[156:159], v[144:147], v[96:111]
    v_mfma_f32_32x32x16_bf16 v[112:127], v[156:159], v[148:151], v[112:127]
    s_waitcnt lgkmcnt(10)
    v_mfma_f32_16x16x32_bf16 v[248:251], v[244:247], v[168:171], v[248:251]
    v_mfma_f32_32x32x16_bf16 v[64:79], v[168:171], v[160:163], v[64:79]
    ds_read_b128 v[144:147], v235 offset:0
    ds_read_b64_tr_b16 v[152:153], v240 offset:12288
    ds_read_b64_tr_b16 v[154:155], v240 offset:13312
    v_mfma_f32_32x32x16_bf16 v[80:95], v[168:171], v[164:167], v[80:95]
    ds_read_b128 v[148:151], v235 offset:4096
    ds_read_b64_tr_b16 v[156:157], v242 offset:12288
    ds_read_b64_tr_b16 v[158:159], v242 offset:13312
    v_mfma_f32_32x32x16_bf16 v[96:111], v[172:175], v[160:163], v[96:111]
    v_mfma_f32_32x32x16_bf16 v[112:127], v[172:175], v[164:167], v[112:127]
    s_waitcnt lgkmcnt(6)
    v_mfma_f32_16x16x32_bf16 v[248:251], v[244:247], v[136:139], v[248:251]
    v_mfma_f32_32x32x16_bf16 v[64:79], v[136:139], v[128:131], v[64:79]
    v_mfma_f32_32x32x16_bf16 v[80:95], v[136:139], v[132:135], v[80:95]
    v_mfma_f32_32x32x16_bf16 v[96:111], v[140:143], v[128:131], v[96:111]
    v_mfma_f32_32x32x16_bf16 v[112:127], v[140:143], v[132:135], v[112:127]
    s_waitcnt lgkmcnt(0)
    s_barrier
    v_mfma_f32_16x16x32_bf16 v[248:251], v[244:247], v[152:155], v[248:251]
    v_mfma_f32_32x32x16_bf16 v[64:79], v[152:155], v[144:147], v[64:79]
    ds_read_b128 v[160:163], v232 offset:32768
    ds_read_b64_tr_b16 v[168:169], v240 offset:32768
    ds_read_b64_tr_b16 v[170:171], v240 offset:33792
    v_mfma_f32_32x32x16_bf16 v[80:95], v[152:155], v[148:151], v[80:95]
    ds_read_b128 v[164:167], v232 offset:36864
    ds_read_b64_tr_b16 v[172:173], v242 offset:32768
    ds_read_b64_tr_b16 v[174:175], v242 offset:33792
    v_mfma_f32_32x32x16_bf16 v[96:111], v[156:159], v[144:147], v[96:111]
    ds_read_b128 v[128:131], v233 offset:32768
    ds_read_b64_tr_b16 v[136:137], v240 offset:36864
    ds_read_b64_tr_b16 v[138:139], v240 offset:37888
    v_mfma_f32_32x32x16_bf16 v[112:127], v[156:159], v[148:151], v[112:127]
    ds_read_b128 v[132:135], v233 offset:36864
    ds_read_b64_tr_b16 v[140:141], v242 offset:36864
    ds_read_b64_tr_b16 v[142:143], v242 offset:37888
    s_waitcnt lgkmcnt(6)
    v_mfma_f32_16x16x32_bf16 v[248:251], v[244:247], v[168:171], v[248:251]
    v_mfma_f32_32x32x16_bf16 v[64:79], v[168:171], v[160:163], v[64:79]
    ds_read_b128 v[144:147], v234 offset:32768
    ds_read_b64_tr_b16 v[152:153], v240 offset:40960
    ds_read_b64_tr_b16 v[154:155], v240 offset:41984
    v_mfma_f32_32x32x16_bf16 v[80:95], v[168:171], v[164:167], v[80:95]
    ds_read_b128 v[148:151], v234 offset:36864
    ds_read_b64_tr_b16 v[156:157], v242 offset:40960
    ds_read_b64_tr_b16 v[158:159], v242 offset:41984
    v_mfma_f32_32x32x16_bf16 v[96:111], v[172:175], v[160:163], v[96:111]
    v_mfma_f32_32x32x16_bf16 v[112:127], v[172:175], v[164:167], v[112:127]
    s_waitcnt lgkmcnt(6)
    v_mfma_f32_16x16x32_bf16 v[248:251], v[244:247], v[136:139], v[248:251]
    v_mfma_f32_32x32x16_bf16 v[64:79], v[136:139], v[128:131], v[64:79]
    ds_read_b128 v[160:163], v235 offset:32768
    ds_read_b64_tr_b16 v[168:169], v240 offset:45056
    ds_read_b64_tr_b16 v[170:171], v240 offset:46080
    v_mfma_f32_32x32x16_bf16 v[80:95], v[136:139], v[132:135], v[80:95]
    ds_read_b128 v[164:167], v235 offset:36864
    ds_read_b64_tr_b16 v[172:173], v242 offset:45056
    ds_read_b64_tr_b16 v[174:175], v242 offset:46080
    v_mfma_f32_32x32x16_bf16 v[96:111], v[140:143], v[128:131], v[96:111]
    v_mfma_f32_32x32x16_bf16 v[112:127], v[140:143], v[132:135], v[112:127]
    s_waitcnt lgkmcnt(6)
    v_mfma_f32_16x16x32_bf16 v[248:251], v[244:247], v[152:155], v[248:251]
    v_mfma_f32_32x32x16_bf16 v[64:79], v[152:155], v[144:147], v[64:79]
    v_cmp_ne_u32 s[18:19], s96, v211
    v_cmp_ne_u32 s[14:15], s96, v215
    v_cmp_ne_u32 s[20:21], s96, v217
    v_cmp_ne_u32 s[94:95], s96, v221
    v_perm_b32 v211, v209, v208, s16
    v_mfma_f32_32x32x16_bf16 v[80:95], v[152:155], v[148:151], v[80:95]
    v_perm_b32 v215, v213, v212, s16
    s_or_b32 s18, s18, s14
    s_or_b64 s[20:21], s[20:21], s[94:95]
    s_or_b32 s18, s18, s20
    s_or_b32 s18, s18, s21
    v_mfma_f32_32x32x16_bf16 v[96:111], v[156:159], v[144:147], v[96:111]
    v_mfma_f32_32x32x16_bf16 v[112:127], v[156:159], v[148:151], v[112:127]
    s_waitcnt lgkmcnt(0)
    s_barrier
    v_mfma_f32_16x16x32_bf16 v[248:251], v[244:247], v[168:171], v[248:251]
    v_mfma_f32_32x32x16_bf16 v[64:79], v[168:171], v[160:163], v[64:79]
    ds_read_b128 v[128:131], v236 offset:0
    ds_read_b64_tr_b16 v[136:137], v241 offset:0
    ds_read_b64_tr_b16 v[138:139], v241 offset:1024
    v_mfma_f32_32x32x16_bf16 v[80:95], v[168:171], v[164:167], v[80:95]
    ds_read_b128 v[132:135], v236 offset:4096
    ds_read_b64_tr_b16 v[140:141], v243 offset:0
    ds_read_b64_tr_b16 v[142:143], v243 offset:1024
    v_mfma_f32_32x32x16_bf16 v[96:111], v[172:175], v[160:163], v[96:111]
    ds_read_b128 v[144:147], v237 offset:0
    ds_read_b64_tr_b16 v[152:153], v241 offset:4096
    ds_read_b64_tr_b16 v[154:155], v241 offset:5120
    v_mfma_f32_32x32x16_bf16 v[112:127], v[172:175], v[164:167], v[112:127]
    ds_read_b128 v[148:151], v237 offset:4096
    ds_read_b64_tr_b16 v[156:157], v243 offset:4096
    ds_read_b64_tr_b16 v[158:159], v243 offset:5120
    s_waitcnt lgkmcnt(6)
    v_mfma_f32_16x16x32_bf16 v[248:251], v[244:247], v[136:139], v[248:251]
    v_mfma_f32_32x32x16_bf16 v[64:79], v[136:139], v[128:131], v[64:79]
    ds_read_b128 v[160:163], v238 offset:0
    ds_read_b64_tr_b16 v[168:169], v241 offset:8192
    ds_read_b64_tr_b16 v[170:171], v241 offset:9216
    v_mfma_f32_32x32x16_bf16 v[80:95], v[136:139], v[132:135], v[80:95]
    ds_read_b128 v[164:167], v238 offset:4096
    ds_read_b64_tr_b16 v[172:173], v243 offset:8192
    ds_read_b64_tr_b16 v[174:175], v243 offset:9216
    v_mfma_f32_32x32x16_bf16 v[96:111], v[140:143], v[128:131], v[96:111]
    v_mfma_f32_32x32x16_bf16 v[112:127], v[140:143], v[132:135], v[112:127]
    s_waitcnt lgkmcnt(6)
    v_mfma_f32_16x16x32_bf16 v[248:251], v[244:247], v[152:155], v[248:251]
    v_mfma_f32_32x32x16_bf16 v[64:79], v[152:155], v[144:147], v[64:79]
    ds_read_b128 v[128:131], v239 offset:0
    ds_read_b64_tr_b16 v[136:137], v241 offset:12288
    ds_read_b64_tr_b16 v[138:139], v241 offset:13312
    v_mfma_f32_32x32x16_bf16 v[80:95], v[152:155], v[148:151], v[80:95]
    ds_read_b128 v[132:135], v239 offset:4096
    ds_read_b64_tr_b16 v[140:141], v243 offset:12288
    ds_read_b64_tr_b16 v[142:143], v243 offset:13312
    v_mfma_f32_32x32x16_bf16 v[96:111], v[156:159], v[144:147], v[96:111]
    v_mfma_f32_32x32x16_bf16 v[112:127], v[156:159], v[148:151], v[112:127]
    s_waitcnt lgkmcnt(6)
    v_mfma_f32_16x16x32_bf16 v[248:251], v[244:247], v[168:171], v[248:251]
    v_mfma_f32_32x32x16_bf16 v[64:79], v[168:171], v[160:163], v[64:79]
    ds_read_b32 v58, v61 offset:272
    v_mfma_f32_32x32x16_bf16 v[80:95], v[168:171], v[164:167], v[80:95]
    v_mfma_f32_32x32x16_bf16 v[96:111], v[172:175], v[160:163], v[96:111]
    v_mfma_f32_32x32x16_bf16 v[112:127], v[172:175], v[164:167], v[112:127]
    s_waitcnt lgkmcnt(0)
    v_cmp_ne_u32 vcc, s96, v58
    s_cbranch_vccz L_rdy_31
    s_mov_b32 s100, 400000
L_lw_32:
    ds_read_b32 v58, v61 offset:272
    s_waitcnt lgkmcnt(0)
    v_cmp_ne_u32 vcc, s96, v58
    s_cbranch_vccz L_lwd_33
    s_sub_u32 s100, s100, 1
    s_cbranch_scc1 L_lwd_33
    s_sleep 1
    s_branch L_lw_32
L_lwd_33:
L_rdy_31:
    v_mfma_f32_16x16x32_bf16 v[248:251], v[244:247], v[136:139], v[248:251]
    v_mfma_f32_32x32x16_bf16 v[64:79], v[136:139], v[128:131], v[64:79]
    ds_read_b128 v[144:147], v236 offset:32768
    ds_read_b64_tr_b16 v[152:153], v241 offset:32768
    ds_read_b64_tr_b16 v[154:155], v241 offset:33792
    v_mfma_f32_32x32x16_bf16 v[80:95], v[136:139], v[132:135], v[80:95]
    ds_read_b128 v[148:151], v236 offset:36864
    ds_read_b64_tr_b16 v[156:157], v243 offset:32768
    ds_read_b64_tr_b16 v[158:159], v243 offset:33792
    v_mfma_f32_32x32x16_bf16 v[96:111], v[140:143], v[128:131], v[96:111]
    ds_read_b128 v[160:163], v237 offset:32768
    ds_read_b64_tr_b16 v[168:169], v241 offset:36864
    ds_read_b64_tr_b16 v[170:171], v241 offset:37888
    v_mfma_f32_32x32x16_bf16 v[112:127], v[140:143], v[132:135], v[112:127]
    ds_read_b128 v[164:167], v237 offset:36864
    ds_read_b64_tr_b16 v[172:173], v243 offset:36864
    ds_read_b64_tr_b16 v[174:175], v243 offset:37888
    ds_write_b32 v60, v62 offset:240
    s_waitcnt lgkmcnt(7)
    v_mfma_f32_16x16x32_bf16 v[248:251], v[244:247], v[152:155], v[248:251]
    v_mfma_f32_32x32x16_bf16 v[64:79], v[152:155], v[144:147], v[64:79]
    ds_read_b128 v[128:131], v238 offset:32768
    ds_read_b64_tr_b16 v[136:137], v241 offset:40960
    ds_read_b64_tr_b16 v[138:139], v241 offset:41984
    v_mfma_f32_32x32x16_bf16 v[80:95], v[152:155], v[148:151], v[80:95]
    ds_read_b128 v[132:135], v238 offset:36864
    ds_read_b64_tr_b16 v[140:141], v243 offset:40960
    ds_read_b64_tr_b16 v[142:143], v243 offset:41984
    v_mfma_f32_32x32x16_bf16 v[96:111], v[156:159], v[144:147], v[96:111]
    v_mfma_f32_32x32x16_bf16 v[112:127], v[156:159], v[148:151], v[112:127]
    s_waitcnt lgkmcnt(7)
    v_mfma_f32_16x16x32_bf16 v[248:251], v[244:247], v[168:171], v[248:251]
    v_mfma_f32_32x32x16_bf16 v[64:79], v[168:171], v[160:163], v[64:79]
    ds_read_b128 v[144:147], v239 offset:32768
    ds_read_b64_tr_b16 v[152:153], v241 offset:45056
    ds_read_b64_tr_b16 v[154:155], v241 offset:46080
    v_mfma_f32_32x32x16_bf16 v[80:95], v[168:171], v[164:167], v[80:95]
    ds_read_b128 v[148:151], v239 offset:36864
    ds_read_b64_tr_b16 v[156:157], v243 offset:45056
    ds_read_b64_tr_b16 v[158:159], v243 offset:46080
    v_mfma_f32_32x32x16_bf16 v[96:111], v[172:175], v[160:163], v[96:111]
    v_mfma_f32_32x32x16_bf16 v[112:127], v[172:175], v[164:167], v[112:127]
    s_waitcnt lgkmcnt(6)
    v_mfma_f32_16x16x32_bf16 v[248:251], v[244:247], v[136:139], v[248:251]
    v_mfma_f32_32x32x16_bf16 v[64:79], v[136:139], v[128:131], v[64:79]
    v_mfma_f32_32x32x16_bf16 v[80:95], v[136:139], v[132:135], v[80:95]
    v_mfma_f32_32x32x16_bf16 v[96:111], v[140:143], v[128:131], v[96:111]
    v_mfma_f32_32x32x16_bf16 v[112:127], v[140:143], v[132:135], v[112:127]
    s_waitcnt lgkmcnt(0)
    v_mfma_f32_16x16x32_bf16 v[248:251], v[244:247], v[152:155], v[248:251]
    v_mfma_f32_32x32x16_bf16 v[64:79], v[152:155], v[144:147], v[64:79]
    ds_write_b32 v60, v62 offset:32
    v_cmp_gt_u32 vcc, 16, v9
    s_nop 4
    v_cndmask_b32 v2, v249, v248, vcc
    v_cvt_pk_bf16_f32 v200, v2, v2
    v_and_b32 v201, s92, v200
    v_sub_f32 v201, v2, v201
    v_cvt_pk_bf16_f32 v200, v2, v201
    v_and_b32 v203, s92, v200
    v_sub_f32 v203, v201, v203
    v_cvt_pk_bf16_f32 v203, v203, v201
    v_mfma_f32_32x32x16_bf16 v[80:95], v[152:155], v[148:151], v[80:95]
    v_and_b32 v201, 0xffff, v200
    v_lshl_or_b32 v201, v59, 16, v201
    v_lshl_or_b32 v202, v59, 16, v59
    ds_write_b128 v23, v[200:203]
    ds_write_b32 v60, v62 offset:48
    v_mfma_f32_32x32x16_bf16 v[96:111], v[156:159], v[144:147], v[96:111]
    v_mfma_f32_32x32x16_bf16 v[112:127], v[156:159], v[148:151], v[112:127]
    s_mov_b32 s100, 40000
L_aux_34:
    s_cmp_eq_u32 s18, 0
    s_cbranch_scc1 L_auxd_35
    s_sub_u32 s100, s100, 1
    s_cbranch_scc1 L_auxd_35
    buffer_load_dwordx4 v[208:211], v22, s[44:47], s23 offen offset:0 sc1
    buffer_load_dwordx4 v[216:219], v26, s[44:47], s23 offen offset:16 sc1
    buffer_load_dwordx4 v[212:215], v22, s[44:47], s23 offen offset:2048 sc1
    buffer_load_dwordx4 v[220:223], v26, s[44:47], s23 offen offset:2064 sc1
    s_waitcnt vmcnt(0)
    v_cmp_ne_u32 s[18:19], s96, v211
    v_cmp_ne_u32 s[14:15], s96, v215
    v_cmp_ne_u32 s[20:21], s96, v217
    v_cmp_ne_u32 s[94:95], s96, v221
    v_perm_b32 v211, v209, v208, s16
    v_perm_b32 v215, v213, v212, s16
    s_or_b32 s18, s18, s14
    s_or_b64 s[20:21], s[20:21], s[94:95]
    s_or_b32 s18, s18, s20
    s_or_b32 s18, s18, s21
    s_branch L_aux_34
L_auxd_35:
    v_mov_b32 v28, v219
    v_mov_b32 v30, v223
    v_mfma_f32_32x32x16_bf16 v[64:79], v[200:203], v[208:211], v[64:79]
    v_mfma_f32_32x32x16_bf16 v[80:95], v[200:203], v[212:215], v[80:95]
    s_nop 10
    v_pk_mul_f32 v[128:129], v[64:65], v[64:65]
    v_pk_mul_f32 v[130:131], v[66:67], v[66:67]
    v_pk_mul_f32 v[132:133], v[68:69], v[68:69]
    v_pk_mul_f32 v[134:135], v[70:71], v[70:71]
    v_pk_fma_f32 v[128:129], v[128:129], v[218:219], v[216:217] op_sel_hi:[1,0,0]
    v_pk_fma_f32 v[130:131], v[130:131], v[218:219], v[216:217] op_sel_hi:[1,0,0]
    v_pk_fma_f32 v[132:133], v[132:133], v[218:219], v[216:217] op_sel_hi:[1,0,0]
    v_pk_fma_f32 v[134:135], v[134:135], v[218:219], v[216:217] op_sel_hi:[1,0,0]
    v_pk_mul_f32 v[128:129], v[128:129], v[64:65]
    v_pk_mul_f32 v[130:131], v[130:131], v[66:67]
    v_pk_mul_f32 v[132:133], v[132:133], v[68:69]
    v_pk_mul_f32 v[134:135], v[134:135], v[70:71]
    v_exp_f32 v128, v128
    v_exp_f32 v129, v129
    v_exp_f32 v130, v130
    v_exp_f32 v131, v131
    v_exp_f32 v132, v132
    v_exp_f32 v133, v133
    v_exp_f32 v134, v134
    v_exp_f32 v135, v135
    v_pk_fma_f32 v[128:129], v[128:129], v[28:29], v[28:29] op_sel_hi:[1,0,0]
    v_pk_fma_f32 v[130:131], v[130:131], v[28:29], v[28:29] op_sel_hi:[1,0,0]
    v_pk_fma_f32 v[132:133], v[132:133], v[28:29], v[28:29] op_sel_hi:[1,0,0]
    v_pk_fma_f32 v[134:135], v[134:135], v[28:29], v[28:29] op_sel_hi:[1,0,0]
    v_rcp_f32 v128, v128
    v_rcp_f32 v129, v129
    v_rcp_f32 v130, v130
    v_rcp_f32 v131, v131
    v_rcp_f32 v132, v132
    v_rcp_f32 v133, v133
    v_rcp_f32 v134, v134
    v_rcp_f32 v135, v135
    v_pk_mul_f32 v[128:129], v[128:129], v[64:65]
    v_pk_mul_f32 v[130:131], v[130:131], v[66:67]
    v_pk_mul_f32 v[132:133], v[132:133], v[68:69]
    v_pk_mul_f32 v[134:135], v[134:135], v[70:71]
    v_cvt_pk_bf16_f32 v136, v128, v129
    v_cvt_pk_bf16_f32 v137, v130, v131
    v_cvt_pk_bf16_f32 v138, v132, v133
    v_cvt_pk_bf16_f32 v139, v134, v135
    buffer_store_dwordx4 v[136:139], v8, s[44:47], s26 offen offset:0 sc1
    ds_read_b32 v58, v25 offset:48
    ds_read_b128 v[204:207], v24
    v_pk_mul_f32 v[144:145], v[72:73], v[72:73]
    v_pk_mul_f32 v[146:147], v[74:75], v[74:75]
    v_pk_mul_f32 v[148:149], v[76:77], v[76:77]
    v_pk_mul_f32 v[150:151], v[78:79], v[78:79]
    v_pk_fma_f32 v[144:145], v[144:145], v[218:219], v[216:217] op_sel_hi:[1,0,0]
    v_pk_fma_f32 v[146:147], v[146:147], v[218:219], v[216:217] op_sel_hi:[1,0,0]
    v_pk_fma_f32 v[148:149], v[148:149], v[218:219], v[216:217] op_sel_hi:[1,0,0]
    v_pk_fma_f32 v[150:151], v[150:151], v[218:219], v[216:217] op_sel_hi:[1,0,0]
    v_pk_mul_f32 v[144:145], v[144:145], v[72:73]
    v_pk_mul_f32 v[146:147], v[146:147], v[74:75]
    v_pk_mul_f32 v[148:149], v[148:149], v[76:77]
    v_pk_mul_f32 v[150:151], v[150:151], v[78:79]
    v_exp_f32 v144, v144
    v_exp_f32 v145, v145
    v_exp_f32 v146, v146
    v_exp_f32 v147, v147
    v_exp_f32 v148, v148
    v_exp_f32 v149, v149
    v_exp_f32 v150, v150
    v_exp_f32 v151, v151
    v_pk_fma_f32 v[144:145], v[144:145], v[28:29], v[28:29] op_sel_hi:[1,0,0]
    v_pk_fma_f32 v[146:147], v[146:147], v[28:29], v[28:29] op_sel_hi:[1,0,0]
    v_pk_fma_f32 v[148:149], v[148:149], v[28:29], v[28:29] op_sel_hi:[1,0,0]
    v_pk_fma_f32 v[150:151], v[150:151], v[28:29], v[28:29] op_sel_hi:[1,0,0]
    v_rcp_f32 v144, v144
    v_rcp_f32 v145, v145
    v_rcp_f32 v146, v146
    v_rcp_f32 v147, v147
    v_rcp_f32 v148, v148
    v_rcp_f32 v149, v149
    v_rcp_f32 v150, v150
    v_rcp_f32 v151, v151
    v_pk_mul_f32 v[144:145], v[144:145], v[72:73]
    v_pk_mul_f32 v[146:147], v[146:147], v[74:75]
    v_pk_mul_f32 v[148:149], v[148:149], v[76:77]
    v_pk_mul_f32 v[150:151], v[150:151], v[78:79]
    v_cvt_pk_bf16_f32 v152, v144, v145
    v_cvt_pk_bf16_f32 v153, v146, v147
    v_cvt_pk_bf16_f32 v154, v148, v149
    v_cvt_pk_bf16_f32 v155, v150, v151
    buffer_store_dwordx4 v[152:155], v8, s[44:47], s26 offen offset:2048 sc1
    s_waitcnt lgkmcnt(0)
    v_cmp_ne_u32 vcc, s96, v58
    s_cbranch_vccz L_g_augok
    s_mov_b32 s100, 400000
L_lw_36:
    ds_read_b32 v2, v25 offset:48
    s_waitcnt lgkmcnt(0)
    v_cmp_ne_u32 vcc, s96, v2
    s_cbranch_vccz L_lwd_37
    s_sub_u32 s100, s100, 1
    s_cbranch_scc1 L_lwd_37
    s_sleep 1
    s_branch L_lw_36
L_lwd_37:
    ds_read_b128 v[204:207], v24
    s_waitcnt lgkmcnt(0)
L_g_augok:
    v_mfma_f32_32x32x16_bf16 v[96:111], v[204:207], v[208:211], v[96:111]
    v_mfma_f32_32x32x16_bf16 v[112:127], v[204:207], v[212:215], v[112:127]
    v_pk_mul_f32 v[128:129], v[80:81], v[80:81]
    v_pk_mul_f32 v[130:131], v[82:83], v[82:83]
    v_pk_mul_f32 v[132:133], v[84:85], v[84:85]
    v_pk_mul_f32 v[134:135], v[86:87], v[86:87]
    v_pk_fma_f32 v[128:129], v[128:129], v[222:223], v[220:221] op_sel_hi:[1,0,0]
    v_pk_fma_f32 v[130:131], v[130:131], v[222:223], v[220:221] op_sel_hi:[1,0,0]
    v_pk_fma_f32 v[132:133], v[132:133], v[222:223], v[220:221] op_sel_hi:[1,0,0]
    v_pk_fma_f32 v[134:135], v[134:135], v[222:223], v[220:221] op_sel_hi:[1,0,0]
    v_pk_mul_f32 v[128:129], v[128:129], v[80:81]
    v_pk_mul_f32 v[130:131], v[130:131], v[82:83]
    v_pk_mul_f32 v[132:133], v[132:133], v[84:85]
    v_pk_mul_f32 v[134:135], v[134:135], v[86:87]
    v_exp_f32 v128, v128
    v_exp_f32 v129, v129
    v_exp_f32 v130, v130
    v_exp_f32 v131, v131
    v_exp_f32 v132, v132
    v_exp_f32 v133, v133
    v_exp_f32 v134, v134
    v_exp_f32 v135, v135
    v_pk_fma_f32 v[128:129], v[128:129], v[30:31], v[30:31] op_sel_hi:[1,0,0]
    v_pk_fma_f32 v[130:131], v[130:131], v[30:31], v[30:31] op_sel_hi:[1,0,0]
    v_pk_fma_f32 v[132:133], v[132:133], v[30:31], v[30:31] op_sel_hi:[1,0,0]
    v_pk_fma_f32 v[134:135], v[134:135], v[30:31], v[30:31] op_sel_hi:[1,0,0]
    v_rcp_f32 v128, v128
    v_rcp_f32 v129, v129
    v_rcp_f32 v130, v130
    v_rcp_f32 v131, v131
    v_rcp_f32 v132, v132
    v_rcp_f32 v133, v133
    v_rcp_f32 v134, v134
    v_rcp_f32 v135, v135
    v_pk_mul_f32 v[128:129], v[128:129], v[80:81]
    v_pk_mul_f32 v[130:131], v[130:131], v[82:83]
    v_pk_mul_f32 v[132:133], v[132:133], v[84:85]
    v_pk_mul_f32 v[134:135], v[134:135], v[86:87]
    v_cvt_pk_bf16_f32 v136, v128, v129
    v_cvt_pk_bf16_f32 v137, v130, v131
    v_cvt_pk_bf16_f32 v138, v132, v133
    v_cvt_pk_bf16_f32 v139, v134, v135
    buffer_store_dwordx4 v[136:139], v8, s[44:47], s26 offen offset:1024 sc1
    v_pk_mul_f32 v[144:145], v[88:89], v[88:89]
    v_pk_mul_f32 v[146:147], v[90:91], v[90:91]
    v_pk_mul_f32 v[148:149], v[92:93], v[92:93]
    v_pk_mul_f32 v[150:151], v[94:95], v[94:95]
    v_pk_fma_f32 v[144:145], v[144:145], v[222:223], v[220:221] op_sel_hi:[1,0,0]
    v_pk_fma_f32 v[146:147], v[146:147], v[222:223], v[220:221] op_sel_hi:[1,0,0]
    v_pk_fma_f32 v[148:149], v[148:149], v[222:223], v[220:221] op_sel_hi:[1,0,0]
    v_pk_fma_f32 v[150:151], v[150:151], v[222:223], v[220:221] op_sel_hi:[1,0,0]
    v_pk_mul_f32 v[144:145], v[144:145], v[88:89]
    v_pk_mul_f32 v[146:147], v[146:147], v[90:91]
    v_pk_mul_f32 v[148:149], v[148:149], v[92:93]
    v_pk_mul_f32 v[150:151], v[150:151], v[94:95]
    v_exp_f32 v144, v144
    v_exp_f32 v145, v145
    v_exp_f32 v146, v146
    v_exp_f32 v147, v147
    v_exp_f32 v148, v148
    v_exp_f32 v149, v149
    v_exp_f32 v150, v150
    v_exp_f32 v151, v151
    v_pk_fma_f32 v[144:145], v[144:145], v[30:31], v[30:31] op_sel_hi:[1,0,0]
    v_pk_fma_f32 v[146:147], v[146:147], v[30:31], v[30:31] op_sel_hi:[1,0,0]
    v_pk_fma_f32 v[148:149], v[148:149], v[30:31], v[30:31] op_sel_hi:[1,0,0]
    v_pk_fma_f32 v[150:151], v[150:151], v[30:31], v[30:31] op_sel_hi:[1,0,0]
    v_rcp_f32 v144, v144
    v_rcp_f32 v145, v145
    v_rcp_f32 v146, v146
    v_rcp_f32 v147, v147
    v_rcp_f32 v148, v148
    v_rcp_f32 v149, v149
    v_rcp_f32 v150, v150
    v_rcp_f32 v151, v151
    v_pk_mul_f32 v[144:145], v[144:145], v[88:89]
    v_pk_mul_f32 v[146:147], v[146:147], v[90:91]
    v_pk_mul_f32 v[148:149], v[148:149], v[92:93]
    v_pk_mul_f32 v[150:151], v[150:151], v[94:95]
    v_cvt_pk_bf16_f32 v152, v144, v145
    v_cvt_pk_bf16_f32 v153, v146, v147
    v_cvt_pk_bf16_f32 v154, v148, v149
    v_cvt_pk_bf16_f32 v155, v150, v151
    buffer_store_dwordx4 v[152:155], v8, s[44:47], s26 offen offset:3072 sc1
    v_pk_mul_f32 v[128:129], v[96:97], v[96:97]
    v_pk_mul_f32 v[130:131], v[98:99], v[98:99]
    v_pk_mul_f32 v[132:133], v[100:101], v[100:101]
    v_pk_mul_f32 v[134:135], v[102:103], v[102:103]
    v_pk_fma_f32 v[128:129], v[128:129], v[218:219], v[216:217] op_sel_hi:[1,0,0]
    v_pk_fma_f32 v[130:131], v[130:131], v[218:219], v[216:217] op_sel_hi:[1,0,0]
    v_pk_fma_f32 v[132:133], v[132:133], v[218:219], v[216:217] op_sel_hi:[1,0,0]
    v_pk_fma_f32 v[134:135], v[134:135], v[218:219], v[216:217] op_sel_hi:[1,0,0]
    v_pk_mul_f32 v[128:129], v[128:129], v[96:97]
    v_pk_mul_f32 v[130:131], v[130:131], v[98:99]
    v_pk_mul_f32 v[132:133], v[132:133], v[100:101]
    v_pk_mul_f32 v[134:135], v[134:135], v[102:103]
    v_exp_f32 v128, v128
    v_exp_f32 v129, v129
    v_exp_f32 v130, v130
    v_exp_f32 v131, v131
    v_exp_f32 v132, v132
    v_exp_f32 v133, v133
    v_exp_f32 v134, v134
    v_exp_f32 v135, v135
    v_pk_fma_f32 v[128:129], v[128:129], v[28:29], v[28:29] op_sel_hi:[1,0,0]
    v_pk_fma_f32 v[130:131], v[130:131], v[28:29], v[28:29] op_sel_hi:[1,0,0]
    v_pk_fma_f32 v[132:133], v[132:133], v[28:29], v[28:29] op_sel_hi:[1,0,0]
    v_pk_fma_f32 v[134:135], v[134:135], v[28:29], v[28:29] op_sel_hi:[1,0,0]
    v_rcp_f32 v128, v128
    v_rcp_f32 v129, v129
    v_rcp_f32 v130, v130
    v_rcp_f32 v131, v131
    v_rcp_f32 v132, v132
    v_rcp_f32 v133, v133
    v_rcp_f32 v134, v134
    v_rcp_f32 v135, v135
    v_pk_mul_f32 v[128:129], v[128:129], v[96:97]
    v_pk_mul_f32 v[130:131], v[130:131], v[98:99]
    v_pk_mul_f32 v[132:133], v[132:133], v[100:101]
    v_pk_mul_f32 v[134:135], v[134:135], v[102:103]
    v_cvt_pk_bf16_f32 v136, v128, v129
    v_cvt_pk_bf16_f32 v137, v130, v131
    v_cvt_pk_bf16_f32 v138, v132, v133
    v_cvt_pk_bf16_f32 v139, v134, v135
    buffer_store_dwordx4 v[136:139], v8, s[44:47], s27 offen offset:0 sc1
    v_pk_mul_f32 v[144:145], v[104:105], v[104:105]
    v_pk_mul_f32 v[146:147], v[106:107], v[106:107]
    v_pk_mul_f32 v[148:149], v[108:109], v[108:109]
    v_pk_mul_f32 v[150:151], v[110:111], v[110:111]
    v_pk_fma_f32 v[144:145], v[144:145], v[218:219], v[216:217] op_sel_hi:[1,0,0]
    v_pk_fma_f32 v[146:147], v[146:147], v[218:219], v[216:217] op_sel_hi:[1,0,0]
    v_pk_fma_f32 v[148:149], v[148:149], v[218:219], v[216:217] op_sel_hi:[1,0,0]
    v_pk_fma_f32 v[150:151], v[150:151], v[218:219], v[216:217] op_sel_hi:[1,0,0]
    v_pk_mul_f32 v[144:145], v[144:145], v[104:105]
    v_pk_mul_f32 v[146:147], v[146:147], v[106:107]
    v_pk_mul_f32 v[148:149], v[148:149], v[108:109]
    v_pk_mul_f32 v[150:151], v[150:151], v[110:111]
    v_exp_f32 v144, v144
    v_exp_f32 v145, v145
    v_exp_f32 v146, v146
    v_exp_f32 v147, v147
    v_exp_f32 v148, v148
    v_exp_f32 v149, v149
    v_exp_f32 v150, v150
    v_exp_f32 v151, v151
    v_pk_fma_f32 v[144:145], v[144:145], v[28:29], v[28:29] op_sel_hi:[1,0,0]
    v_pk_fma_f32 v[146:147], v[146:147], v[28:29], v[28:29] op_sel_hi:[1,0,0]
    v_pk_fma_f32 v[148:149], v[148:149], v[28:29], v[28:29] op_sel_hi:[1,0,0]
    v_pk_fma_f32 v[150:151], v[150:151], v[28:29], v[28:29] op_sel_hi:[1,0,0]
    v_rcp_f32 v144, v144
    v_rcp_f32 v145, v145
    v_rcp_f32 v146, v146
    v_rcp_f32 v147, v147
    v_rcp_f32 v148, v148
    v_rcp_f32 v149, v149
    v_rcp_f32 v150, v150
    v_rcp_f32 v151, v151
    v_pk_mul_f32 v[144:145], v[144:145], v[104:105]
    v_pk_mul_f32 v[146:147], v[146:147], v[106:107]
    v_pk_mul_f32 v[148:149], v[148:149], v[108:109]
    v_pk_mul_f32 v[150:151], v[150:151], v[110:111]
    v_cvt_pk_bf16_f32 v152, v144, v145
    v_cvt_pk_bf16_f32 v153, v146, v147
    v_cvt_pk_bf16_f32 v154, v148, v149
    v_cvt_pk_bf16_f32 v155, v150, v151
    buffer_store_dwordx4 v[152:155], v8, s[44:47], s27 offen offset:2048 sc1
    v_pk_mul_f32 v[128:129], v[112:113], v[112:113]
    v_pk_mul_f32 v[130:131], v[114:115], v[114:115]
    v_pk_mul_f32 v[132:133], v[116:117], v[116:117]
    v_pk_mul_f32 v[134:135], v[118:119], v[118:119]
    v_pk_fma_f32 v[128:129], v[128:129], v[222:223], v[220:221] op_sel_hi:[1,0,0]
    v_pk_fma_f32 v[130:131], v[130:131], v[222:223], v[220:221] op_sel_hi:[1,0,0]
    v_pk_fma_f32 v[132:133], v[132:133], v[222:223], v[220:221] op_sel_hi:[1,0,0]
    v_pk_fma_f32 v[134:135], v[134:135], v[222:223], v[220:221] op_sel_hi:[1,0,0]
    v_pk_mul_f32 v[128:129], v[128:129], v[112:113]
    v_pk_mul_f32 v[130:131], v[130:131], v[114:115]
    v_pk_mul_f32 v[132:133], v[132:133], v[116:117]
    v_pk_mul_f32 v[134:135], v[134:135], v[118:119]
    v_exp_f32 v128, v128
    v_exp_f32 v129, v129
    v_exp_f32 v130, v130
    v_exp_f32 v131, v131
    v_exp_f32 v132, v132
    v_exp_f32 v133, v133
    v_exp_f32 v134, v134
    v_exp_f32 v135, v135
    v_pk_fma_f32 v[128:129], v[128:129], v[30:31], v[30:31] op_sel_hi:[1,0,0]
    v_pk_fma_f32 v[130:131], v[130:131], v[30:31], v[30:31] op_sel_hi:[1,0,0]
    v_pk_fma_f32 v[132:133], v[132:133], v[30:31], v[30:31] op_sel_hi:[1,0,0]
    v_pk_fma_f32 v[134:135], v[134:135], v[30:31], v[30:31] op_sel_hi:[1,0,0]
    v_rcp_f32 v128, v128
    v_rcp_f32 v129, v129
    v_rcp_f32 v130, v130
    v_rcp_f32 v131, v131
    v_rcp_f32 v132, v132
    v_rcp_f32 v133, v133
    v_rcp_f32 v134, v134
    v_rcp_f32 v135, v135
    v_pk_mul_f32 v[128:129], v[128:129], v[112:113]
    v_pk_mul_f32 v[130:131], v[130:131], v[114:115]
    v_pk_mul_f32 v[132:133], v[132:133], v[116:117]
    v_pk_mul_f32 v[134:135], v[134:135], v[118:119]
    v_cvt_pk_bf16_f32 v136, v128, v129
    v_cvt_pk_bf16_f32 v137, v130, v131
    v_cvt_pk_bf16_f32 v138, v132, v133
    v_cvt_pk_bf16_f32 v139, v134, v135
    buffer_store_dwordx4 v[136:139], v8, s[44:47], s27 offen offset:1024 sc1
    v_pk_mul_f32 v[144:145], v[120:121], v[120:121]
    v_pk_mul_f32 v[146:147], v[122:123], v[122:123]
    v_pk_mul_f32 v[148:149], v[124:125], v[124:125]
    v_pk_mul_f32 v[150:151], v[126:127], v[126:127]
    v_pk_fma_f32 v[144:145], v[144:145], v[222:223], v[220:221] op_sel_hi:[1,0,0]
    v_pk_fma_f32 v[146:147], v[146:147], v[222:223], v[220:221] op_sel_hi:[1,0,0]
    v_pk_fma_f32 v[148:149], v[148:149], v[222:223], v[220:221] op_sel_hi:[1,0,0]
    v_pk_fma_f32 v[150:151], v[150:151], v[222:223], v[220:221] op_sel_hi:[1,0,0]
    v_pk_mul_f32 v[144:145], v[144:145], v[120:121]
    v_pk_mul_f32 v[146:147], v[146:147], v[122:123]
    v_pk_mul_f32 v[148:149], v[148:149], v[124:125]
    v_pk_mul_f32 v[150:151], v[150:151], v[126:127]
    ds_write_b32 v60, v62 offset:64
    v_exp_f32 v144, v144
    v_exp_f32 v145, v145
    v_exp_f32 v146, v146
    v_exp_f32 v147, v147
    v_exp_f32 v148, v148
    v_exp_f32 v149, v149
    v_exp_f32 v150, v150
    v_exp_f32 v151, v151
    v_fma_f32 v144, v144, v223, v223
    v_fma_f32 v145, v145, v223, v223
    v_fma_f32 v146, v146, v223, v223
    v_fma_f32 v147, v147, v223, v223
    v_fma_f32 v148, v148, v223, v223
    v_fma_f32 v149, v149, v223, v223
    v_fma_f32 v150, v150, v223, v223
    v_fma_f32 v151, v151, v223, v223
    v_rcp_f32 v144, v144
    v_rcp_f32 v145, v145
    v_rcp_f32 v146, v146
    v_rcp_f32 v147, v147
    v_rcp_f32 v148, v148
    v_rcp_f32 v149, v149
    v_rcp_f32 v150, v150
    v_rcp_f32 v151, v151
    v_mul_f32 v144, v144, v120
    v_mul_f32 v145, v145, v121
    v_mul_f32 v146, v146, v122
    v_mul_f32 v147, v147, v123
    v_mul_f32 v148, v148, v124
    v_mul_f32 v149, v149, v125
    v_mul_f32 v150, v150, v126
    v_mul_f32 v151, v151, v127
    v_cvt_pk_bf16_f32 v152, v144, v145
    v_cvt_pk_bf16_f32 v153, v146, v147
    v_cvt_pk_bf16_f32 v154, v148, v149
    v_cvt_pk_bf16_f32 v155, v150, v151
    buffer_store_dwordx4 v[152:155], v8, s[44:47], s27 offen offset:3072 sc1
    s_lshl_b32 s15, s13, 12
    s_mul_i32 s17, s13, 14
    s_add_u32 s16, s17, s12
    s_lshl_b32 s16, s16, 15
    s_add_u32 s17, s17, 14
    s_lshl_b32 s17, s17, 15
    s_add_u32 s16, s16, 131072
    s_sub_u32 s11, s16, 458752
    s_cmp_ge_u32 s16, s17
    s_cselect_b32 s16, s11, s16
    s_mov_b32 s30, s16
    s_add_u32 s16, s16, 32768
    s_sub_u32 s11, s16, 458752
    s_cmp_ge_u32 s16, s17
    s_cselect_b32 s16, s11, s16
    s_mov_b32 s31, s16
    s_add_u32 s16, s16, 32768
    s_sub_u32 s11, s16, 458752
    s_cmp_ge_u32 s16, s17
    s_cselect_b32 s16, s11, s16
    s_mov_b32 s32, s16
    s_add_u32 s16, s16, 32768
    s_sub_u32 s11, s16, 458752
    s_cmp_ge_u32 s16, s17
    s_cselect_b32 s16, s11, s16
    s_mov_b32 s33, s16
    s_add_u32 s16, s16, 32768
    s_sub_u32 s11, s16, 458752
    s_cmp_ge_u32 s16, s17
    s_cselect_b32 s16, s11, s16
    s_mov_b32 s34, s16
    s_add_u32 s16, s16, 32768
    s_sub_u32 s11, s16, 458752
    s_cmp_ge_u32 s16, s17
    s_cselect_b32 s16, s11, s16
    s_mov_b32 s35, s16
    s_add_u32 s16, s16, 32768
    s_sub_u32 s11, s16, 458752
    s_cmp_ge_u32 s16, s17
    s_cselect_b32 s16, s11, s16
    s_mov_b32 s36, s16
    s_add_u32 s16, s16, 32768
    s_sub_u32 s11, s16, 458752
    s_cmp_ge_u32 s16, s17
    s_cselect_b32 s16, s11, s16
    s_mov_b32 s37, s16
    s_add_u32 s16, s16, 32768
    s_sub_u32 s11, s16, 458752
    s_cmp_ge_u32 s16, s17
    s_cselect_b32 s16, s11, s16
    s_mov_b32 s38, s16
    s_add_u32 s16, s16, 32768
    s_sub_u32 s11, s16, 458752
    s_cmp_ge_u32 s16, s17
    s_cselect_b32 s16, s11, s16
    s_mov_b32 s39, s16
    v_lshl_add_u32 v12, v10, 9, v21
    v_add_u32 v12, s15, v12
    v_add_u32 v13, 0x10000, v12
    s_mul_i32 s23, s8, 56
    s_mul_i32 s11, s13, 14
    s_add_u32 s23, s23, s11
    s_add_u32 s22, s23, s12
    s_add_u32 s23, s23, 14
    s_lshl_b32 s22, s22, 12
    s_lshl_b32 s23, s23, 12
    s_add_u32 s22, s22, 4521984
    s_add_u32 s23, s23, 4521984
    s_lshl_b32 s24, s8, 2
    s_add_u32 s24, s24, s13
    s_lshl_b32 s24, s24, 7
    s_add_u32 s24, s24, 36864
    s_mov_b32 s100, 400000
L_lw_38:
    ds_read_b32 v2, v61 offset:32
    s_waitcnt lgkmcnt(0)
    v_cmp_ne_u32 vcc, s96, v2
    s_cbranch_vccz L_lwd_39
    s_sub_u32 s100, s100, 1
    s_cbranch_scc1 L_lwd_39
    s_sleep 1
    s_branch L_lw_38
L_lwd_39:
    s_waitcnt vmcnt(0)
    s_mov_b64 exec, 1
    buffer_store_dword v62, off, s[44:47], s28 sc1
    s_mov_b64 exec, -1
    s_add_u32 m0, s15, 98304
    s_add_u32 s11, s32, 0
    buffer_load_dwordx4 v11, s[52:55], s11 offen lds
    s_add_u32 m0, s15, 99328
    s_add_u32 s11, s32, 8192
    buffer_load_dwordx4 v11, s[52:55], s11 offen lds
    s_add_u32 m0, s15, 100352
    s_add_u32 s11, s32, 16384
    buffer_load_dwordx4 v11, s[52:55], s11 offen lds
    s_add_u32 m0, s15, 101376
    s_add_u32 s11, s32, 24576
    buffer_load_dwordx4 v11, s[52:55], s11 offen lds
    s_add_u32 m0, s15, 114688
    s_add_u32 s11, s33, 0
    buffer_load_dwordx4 v11, s[52:55], s11 offen lds
    s_add_u32 m0, s15, 115712
    s_add_u32 s11, s33, 8192
    buffer_load_dwordx4 v11, s[52:55], s11 offen lds
    s_add_u32 m0, s15, 116736
    s_add_u32 s11, s33, 16384
    buffer_load_dwordx4 v11, s[52:55], s11 offen lds
    s_add_u32 m0, s15, 117760
    s_add_u32 s11, s33, 24576
    buffer_load_dwordx4 v11, s[52:55], s11 offen lds
L_g_gemm2:
    s_mov_b32 s100, 400000
L_lw_40:
    ds_read_b32 v2, v60 offset:0
    s_waitcnt lgkmcnt(0)
    v_cmp_ne_u32 vcc, s96, v2
    s_cbranch_vccz L_lwd_41
    s_sub_u32 s100, s100, 1
    s_cbranch_scc1 L_lwd_41
    s_sleep 1
    s_branch L_lw_40
L_lwd_41:
L_g_gemm2b:
    ds_read_b64_tr_b16 v[128:129], v12 offset:0
    ds_read_b64_tr_b16 v[130:131], v12 offset:1024
    ds_read_b64_tr_b16 v[132:133], v12 offset:256
    ds_read_b64_tr_b16 v[134:135], v12 offset:1280
    ds_read_b64_tr_b16 v[136:137], v12 offset:2048
    ds_read_b64_tr_b16 v[138:139], v12 offset:3072
    ds_read_b64_tr_b16 v[140:141], v12 offset:2304
    ds_read_b64_tr_b16 v[142:143], v12 offset:3328
    ds_read_b64_tr_b16 v[144:145], v12 offset:16384
    ds_read_b64_tr_b16 v[146:147], v12 offset:17408
    ds_read_b64_tr_b16 v[148:149], v12 offset:16640
    ds_read_b64_tr_b16 v[150:151], v12 offset:17664
    ds_read_b64_tr_b16 v[152:153], v12 offset:18432
    ds_read_b64_tr_b16 v[154:155], v12 offset:19456
    ds_read_b64_tr_b16 v[156:157], v12 offset:18688
    ds_read_b64_tr_b16 v[158:159], v12 offset:19712
    s_waitcnt lgkmcnt(8)
    s_add_u32 m0, s15, 0
    s_add_u32 s11, s34, 0
    buffer_load_dwordx4 v11, s[52:55], s11 offen lds
    s_add_u32 m0, s15, 1024
    s_add_u32 s11, s34, 8192
    buffer_load_dwordx4 v11, s[52:55], s11 offen lds
    s_add_u32 m0, s15, 2048
    s_add_u32 s11, s34, 16384
    buffer_load_dwordx4 v11, s[52:55], s11 offen lds
    s_add_u32 m0, s15, 3072
    s_add_u32 s11, s34, 24576
    buffer_load_dwordx4 v11, s[52:55], s11 offen lds
    ds_read_b64_tr_b16 v[160:161], v12 offset:32768
    ds_read_b64_tr_b16 v[162:163], v12 offset:33792
    ds_read_b64_tr_b16 v[164:165], v12 offset:33024
    ds_read_b64_tr_b16 v[166:167], v12 offset:34048
    ds_read_b64_tr_b16 v[168:169], v12 offset:34816
    ds_read_b64_tr_b16 v[170:171], v12 offset:35840
    ds_read_b64_tr_b16 v[172:173], v12 offset:35072
    ds_read_b64_tr_b16 v[174:175], v12 offset:36096
    s_waitcnt lgkmcnt(8)
    s_add_u32 m0, s15, 16384
    s_add_u32 s11, s35, 0
    buffer_load_dwordx4 v11, s[52:55], s11 offen lds
    s_add_u32 m0, s15, 17408
    s_add_u32 s11, s35, 8192
    buffer_load_dwordx4 v11, s[52:55], s11 offen lds
    s_add_u32 m0, s15, 18432
    s_add_u32 s11, s35, 16384
    buffer_load_dwordx4 v11, s[52:55], s11 offen lds
    s_add_u32 m0, s15, 19456
    s_add_u32 s11, s35, 24576
    buffer_load_dwordx4 v11, s[52:55], s11 offen lds
    ds_read_b64_tr_b16 v[176:177], v12 offset:49152
    ds_read_b64_tr_b16 v[178:179], v12 offset:50176
    ds_read_b64_tr_b16 v[180:181], v12 offset:49408
    ds_read_b64_tr_b16 v[182:183], v12 offset:50432
    ds_read_b64_tr_b16 v[184:185], v12 offset:51200
    ds_read_b64_tr_b16 v[186:187], v12 offset:52224
    ds_read_b64_tr_b16 v[188:189], v12 offset:51456
    ds_read_b64_tr_b16 v[190:191], v12 offset:52480
    s_waitcnt lgkmcnt(8)
    s_add_u32 m0, s15, 32768
    s_add_u32 s11, s36, 0
    buffer_load_dwordx4 v11, s[52:55], s11 offen lds
    s_add_u32 m0, s15, 33792
    s_add_u32 s11, s36, 8192
    buffer_load_dwordx4 v11, s[52:55], s11 offen lds
    s_add_u32 m0, s15, 34816
    s_add_u32 s11, s36, 16384
    buffer_load_dwordx4 v11, s[52:55], s11 offen lds
    s_add_u32 m0, s15, 35840
    s_add_u32 s11, s36, 24576
    buffer_load_dwordx4 v11, s[52:55], s11 offen lds
    ds_read_b64_tr_b16 v[192:193], v13 offset:0
    ds_read_b64_tr_b16 v[194:195], v13 offset:1024
    ds_read_b64_tr_b16 v[196:197], v13 offset:256
    ds_read_b64_tr_b16 v[198:199], v13 offset:1280
    ds_read_b64_tr_b16 v[200:201], v13 offset:2048
    ds_read_b64_tr_b16 v[202:203], v13 offset:3072
    ds_read_b64_tr_b16 v[204:205], v13 offset:2304
    ds_read_b64_tr_b16 v[206:207], v13 offset:3328
    s_waitcnt lgkmcnt(8)
    s_buffer_load_dwordx8 s[60:67], s[44:47], s24 glc
    s_add_u32 m0, s15, 49152
    s_add_u32 s11, s37, 0
    buffer_load_dwordx4 v11, s[52:55], s11 offen lds
    s_add_u32 m0, s15, 50176
    s_add_u32 s11, s37, 8192
    buffer_load_dwordx4 v11, s[52:55], s11 offen lds
    s_add_u32 m0, s15, 51200
    s_add_u32 s11, s37, 16384
    buffer_load_dwordx4 v11, s[52:55], s11 offen lds
    s_add_u32 m0, s15, 52224
    s_add_u32 s11, s37, 24576
    buffer_load_dwordx4 v11, s[52:55], s11 offen lds
    ds_read_b64_tr_b16 v[208:209], v13 offset:16384
    ds_read_b64_tr_b16 v[210:211], v13 offset:17408
    ds_read_b64_tr_b16 v[212:213], v13 offset:16640
    ds_read_b64_tr_b16 v[214:215], v13 offset:17664
    ds_read_b64_tr_b16 v[216:217], v13 offset:18432
    ds_read_b64_tr_b16 v[218:219], v13 offset:19456
    ds_read_b64_tr_b16 v[220:221], v13 offset:18688
    ds_read_b64_tr_b16 v[222:223], v13 offset:19712
    s_mov_b32 s100, 40000
    s_mov_b32 s98, s96
    s_mov_b32 s99, s96
    s_branch L_spw_45
L_spr_44:
    s_sub_u32 s100, s100, 1
    s_cbranch_scc1 L_spd_43
L_sp_42:
    s_buffer_load_dwordx8 s[60:67], s[44:47], s24 glc
L_spw_45:
    s_waitcnt lgkmcnt(0)
    s_cmp_eq_u64 s[60:61], s[98:99]
    s_cbranch_scc0 L_spr_44
    s_cmp_eq_u64 s[62:63], s[98:99]
    s_cbranch_scc0 L_spr_44
    s_cmp_eq_u64 s[64:65], s[98:99]
    s_cbranch_scc0 L_spr_44
    s_cmp_eq_u32 s66, s98
    s_cbranch_scc0 L_spr_44
L_spd_43:
    s_add_u32 s11, s15, 65536
    v_add_u32 v14, s11, v8
    buffer_load_dwordx4 v[16:19], v8, s[44:47], s22 offen offset:0 sc1
    buffer_load_dwordx4 v[20:23], v8, s[44:47], s22 offen offset:1024 sc1
    buffer_load_dwordx4 v[24:27], v8, s[44:47], s22 offen offset:2048 sc1
    buffer_load_dwordx4 v[28:31], v8, s[44:47], s22 offen offset:3072 sc1
    s_add_u32 s22, s22, 4096
    s_sub_u32 s11, s22, 57344
    s_cmp_ge_u32 s22, s23
    s_cselect_b32 s22, s11, s22
    buffer_load_dwordx4 v[32:35], v8, s[44:47], s22 offen offset:0 sc1
    buffer_load_dwordx4 v[36:39], v8, s[44:47], s22 offen offset:1024 sc1
    buffer_load_dwordx4 v[40:43], v8, s[44:47], s22 offen offset:2048 sc1
    buffer_load_dwordx4 v[44:47], v8, s[44:47], s22 offen offset:3072 sc1
    s_add_u32 s22, s22, 4096
    s_sub_u32 s11, s22, 57344
    s_cmp_ge_u32 s22, s23
    s_cselect_b32 s22, s11, s22
    buffer_load_dwordx4 v[48:51], v8, s[44:47], s22 offen offset:0 sc1
    buffer_load_dwordx4 v[52:55], v8, s[44:47], s22 offen offset:1024 sc1
    buffer_load_dwordx4 v[56:59], v8, s[44:47], s22 offen offset:2048 sc1
    buffer_load_dwordx4 v[60:63], v8, s[44:47], s22 offen offset:3072 sc1
    s_add_u32 s22, s22, 4096
    s_sub_u32 s11, s22, 57344
    s_cmp_ge_u32 s22, s23
    s_cselect_b32 s22, s11, s22
    buffer_load_dwordx4 v[224:227], v8, s[44:47], s22 offen offset:0 sc1
    buffer_load_dwordx4 v[228:231], v8, s[44:47], s22 offen offset:1024 sc1
    buffer_load_dwordx4 v[232:235], v8, s[44:47], s22 offen offset:2048 sc1
    buffer_load_dwordx4 v[236:239], v8, s[44:47], s22 offen offset:3072 sc1
    s_add_u32 s22, s22, 4096
    s_sub_u32 s11, s22, 57344
    s_cmp_ge_u32 s22, s23
    s_cselect_b32 s22, s11, s22
    s_setprio 0
    s_waitcnt vmcnt(14)
    v_mfma_f32_32x32x16_bf16 v[64:79], v[128:131], v[16:19], 0
    v_mfma_f32_32x32x16_bf16 v[80:95], v[128:131], v[20:23], 0
    s_add_u32 m0, s15, 65536
    s_add_u32 s14, s38, 0
    buffer_load_dwordx4 v11, s[52:55], s14 offen lds
    v_mfma_f32_32x32x16_bf16 v[96:111], v[132:135], v[16:19], 0
    v_mfma_f32_32x32x16_bf16 v[112:127], v[132:135], v[20:23], 0
    s_add_u32 m0, s15, 66560
    s_add_u32 s14, s38, 8192
    buffer_load_dwordx4 v11, s[52:55], s14 offen lds
    s_waitcnt vmcnt(14)
    v_mfma_f32_32x32x16_bf16 v[64:79], v[136:139], v[24:27], v[64:79]
    buffer_load_dwordx4 v[16:19], v8, s[44:47], s22 offen offset:0 sc1
    v_mfma_f32_32x32x16_bf16 v[80:95], v[136:139], v[28:31], v[80:95]
    s_add_u32 m0, s15, 67584
    s_add_u32 s14, s38, 16384
    buffer_load_dwordx4 v11, s[52:55], s14 offen lds
    v_mfma_f32_32x32x16_bf16 v[96:111], v[140:143], v[24:27], v[96:111]
    buffer_load_dwordx4 v[20:23], v8, s[44:47], s22 offen offset:1024 sc1
    v_mfma_f32_32x32x16_bf16 v[112:127], v[140:143], v[28:31], v[112:127]
    s_add_u32 m0, s15, 68608
    s_add_u32 s14, s38, 24576
    buffer_load_dwordx4 v11, s[52:55], s14 offen lds
    s_waitcnt vmcnt(16)
    v_mfma_f32_32x32x16_bf16 v[64:79], v[144:147], v[32:35], v[64:79]
    ds_read_b64_tr_b16 v[128:129], v13 offset:32768
    buffer_load_dwordx4 v[24:27], v8, s[44:47], s22 offen offset:2048 sc1
    v_mfma_f32_32x32x16_bf16 v[80:95], v[144:147], v[36:39], v[80:95]
    ds_read_b64_tr_b16 v[130:131], v13 offset:33792
    s_add_u32 m0, s15, 81920
    s_add_u32 s14, s39, 0
    buffer_load_dwordx4 v11, s[52:55], s14 offen lds
    v_mfma_f32_32x32x16_bf16 v[96:111], v[148:151], v[32:35], v[96:111]
    ds_read_b64_tr_b16 v[132:133], v13 offset:33024
    buffer_load_dwordx4 v[28:31], v8, s[44:47], s22 offen offset:3072 sc1
    s_add_u32 s22, s22, 4096
    s_sub_u32 s11, s22, 57344
    s_cmp_ge_u32 s22, s23
    s_cselect_b32 s22, s11, s22
    v_mfma_f32_32x32x16_bf16 v[112:127], v[148:151], v[36:39], v[112:127]
    ds_read_b64_tr_b16 v[134:135], v13 offset:34048
    s_add_u32 m0, s15, 82944
    s_add_u32 s14, s39, 8192
    buffer_load_dwordx4 v11, s[52:55], s14 offen lds
    s_waitcnt vmcnt(18)
    v_mfma_f32_32x32x16_bf16 v[64:79], v[152:155], v[40:43], v[64:79]
    ds_read_b64_tr_b16 v[136:137], v13 offset:34816
    buffer_load_dwordx4 v[32:35], v8, s[44:47], s22 offen offset:0 sc1
    v_mfma_f32_32x32x16_bf16 v[80:95], v[152:155], v[44:47], v[80:95]
    ds_read_b64_tr_b16 v[138:139], v13 offset:35840
    s_add_u32 m0, s15, 83968
    s_add_u32 s14, s39, 16384
    buffer_load_dwordx4 v11, s[52:55], s14 offen lds
    v_mfma_f32_32x32x16_bf16 v[96:111], v[156:159], v[40:43], v[96:111]
    ds_read_b64_tr_b16 v[140:141], v13 offset:35072
    buffer_load_dwordx4 v[36:39], v8, s[44:47], s22 offen offset:1024 sc1
    v_mfma_f32_32x32x16_bf16 v[112:127], v[156:159], v[44:47], v[112:127]
    ds_read_b64_tr_b16 v[142:143], v13 offset:36096
    s_add_u32 m0, s15, 84992
    s_add_u32 s14, s39, 24576
    buffer_load_dwordx4 v11, s[52:55], s14 offen lds
    s_waitcnt vmcnt(20)
    v_mfma_f32_32x32x16_bf16 v[64:79], v[160:163], v[48:51], v[64:79]
    ds_read_b64_tr_b16 v[144:145], v13 offset:49152
    buffer_load_dwordx4 v[40:43], v8, s[44:47], s22 offen offset:2048 sc1
    v_mfma_f32_32x32x16_bf16 v[80:95], v[160:163], v[52:55], v[80:95]
    ds_read_b64_tr_b16 v[146:147], v13 offset:50176
    v_mfma_f32_32x32x16_bf16 v[96:111], v[164:167], v[48:51], v[96:111]
    ds_read_b64_tr_b16 v[148:149], v13 offset:49408
    buffer_load_dwordx4 v[44:47], v8, s[44:47], s22 offen offset:3072 sc1
    s_add_u32 s22, s22, 4096
    s_sub_u32 s11, s22, 57344
    s_cmp_ge_u32 s22, s23
    s_cselect_b32 s22, s11, s22
    v_mfma_f32_32x32x16_bf16 v[112:127], v[164:167], v[52:55], v[112:127]
    ds_read_b64_tr_b16 v[150:151], v13 offset:50432
    s_waitcnt vmcnt(20)
    v_mfma_f32_32x32x16_bf16 v[64:79], v[168:171], v[56:59], v[64:79]
    ds_read_b64_tr_b16 v[152:153], v13 offset:51200
    buffer_load_dwordx4 v[48:51], v8, s[44:47], s22 offen offset:0 sc1
    v_mfma_f32_32x32x16_bf16 v[80:95], v[168:171], v[60:63], v[80:95]
    ds_read_b64_tr_b16 v[154:155], v13 offset:52224
    v_mfma_f32_32x32x16_bf16 v[96:111], v[172:175], v[56:59], v[96:111]
    ds_read_b64_tr_b16 v[156:157], v13 offset:51456
    buffer_load_dwordx4 v[52:55], v8, s[44:47], s22 offen offset:1024 sc1
    v_mfma_f32_32x32x16_bf16 v[112:127], v[172:175], v[60:63], v[112:127]
    ds_read_b64_tr_b16 v[158:159], v13 offset:52480
    s_waitcnt vmcnt(20)
    v_mfma_f32_32x32x16_bf16 v[64:79], v[176:179], v[224:227], v[64:79]
    ds_read_b64_tr_b16 v[160:161], v12 offset:0
    buffer_load_dwordx4 v[56:59], v8, s[44:47], s22 offen offset:2048 sc1
    v_mfma_f32_32x32x16_bf16 v[80:95], v[176:179], v[228:231], v[80:95]
    ds_read_b64_tr_b16 v[162:163], v12 offset:1024
    v_mfma_f32_32x32x16_bf16 v[96:111], v[180:183], v[224:227], v[96:111]
    ds_read_b64_tr_b16 v[164:165], v12 offset:256
    buffer_load_dwordx4 v[60:63], v8, s[44:47], s22 offen offset:3072 sc1
    s_add_u32 s22, s22, 4096
    s_sub_u32 s11, s22, 57344
    s_cmp_ge_u32 s22, s23
    s_cselect_b32 s22, s11, s22
    v_mfma_f32_32x32x16_bf16 v[112:127], v[180:183], v[228:231], v[112:127]
    ds_read_b64_tr_b16 v[166:167], v12 offset:1280
    s_waitcnt vmcnt(20)
    v_mfma_f32_32x32x16_bf16 v[64:79], v[184:187], v[232:235], v[64:79]
    ds_read_b64_tr_b16 v[168:169], v12 offset:2048
    buffer_load_dwordx4 v[224:227], v8, s[44:47], s22 offen offset:0 sc1
    v_mfma_f32_32x32x16_bf16 v[80:95], v[184:187], v[236:239], v[80:95]
    ds_read_b64_tr_b16 v[170:171], v12 offset:3072
    v_mfma_f32_32x32x16_bf16 v[96:111], v[188:191], v[232:235], v[96:111]
    ds_read_b64_tr_b16 v[172:173], v12 offset:2304
    buffer_load_dwordx4 v[228:231], v8, s[44:47], s22 offen offset:1024 sc1
    v_mfma_f32_32x32x16_bf16 v[112:127], v[188:191], v[236:239], v[112:127]
    ds_read_b64_tr_b16 v[174:175], v12 offset:3328
    s_waitcnt vmcnt(17)
    v_mfma_f32_32x32x16_bf16 v[64:79], v[192:195], v[16:19], v[64:79]
    ds_read_b64_tr_b16 v[176:177], v12 offset:16384
    buffer_load_dwordx4 v[232:235], v8, s[44:47], s22 offen offset:2048 sc1
    v_mfma_f32_32x32x16_bf16 v[80:95], v[192:195], v[20:23], v[80:95]
    ds_read_b64_tr_b16 v[178:179], v12 offset:17408
    v_mfma_f32_32x32x16_bf16 v[96:111], v[196:199], v[16:19], v[96:111]
    ds_read_b64_tr_b16 v[180:181], v12 offset:16640
    buffer_load_dwordx4 v[236:239], v8, s[44:47], s22 offen offset:3072 sc1
    s_add_u32 s22, s22, 4096
    s_sub_u32 s11, s22, 57344
    s_cmp_ge_u32 s22, s23
    s_cselect_b32 s22, s11, s22
    v_mfma_f32_32x32x16_bf16 v[112:127], v[196:199], v[20:23], v[112:127]
    ds_read_b64_tr_b16 v[182:183], v12 offset:17664
    s_waitcnt vmcnt(15)
    v_mfma_f32_32x32x16_bf16 v[64:79], v[200:203], v[24:27], v[64:79]
    ds_read_b64_tr_b16 v[184:185], v12 offset:18432
    buffer_load_dwordx4 v[16:19], v8, s[44:47], s22 offen offset:0 sc1
    v_mfma_f32_32x32x16_bf16 v[80:95], v[200:203], v[28:31], v[80:95]
    ds_read_b64_tr_b16 v[186:187], v12 offset:19456
    v_mfma_f32_32x32x16_bf16 v[96:111], v[204:207], v[24:27], v[96:111]
    ds_read_b64_tr_b16 v[188:189], v12 offset:18688
    buffer_load_dwordx4 v[20:23], v8, s[44:47], s22 offen offset:1024 sc1
    v_mfma_f32_32x32x16_bf16 v[112:127], v[204:207], v[28:31], v[112:127]
    ds_read_b64_tr_b16 v[190:191], v12 offset:19712
    s_waitcnt vmcnt(13)
    v_mfma_f32_32x32x16_bf16 v[64:79], v[208:211], v[32:35], v[64:79]
    ds_read_b64_tr_b16 v[192:193], v12 offset:32768
    buffer_load_dwordx4 v[24:27], v8, s[44:47], s22 offen offset:2048 sc1
    v_mfma_f32_32x32x16_bf16 v[80:95], v[208:211], v[36:39], v[80:95]
    ds_read_b64_tr_b16 v[194:195], v12 offset:33792
    v_mfma_f32_32x32x16_bf16 v[96:111], v[212:215], v[32:35], v[96:111]
    ds_read_b64_tr_b16 v[196:197], v12 offset:33024
    buffer_load_dwordx4 v[28:31], v8, s[44:47], s22 offen offset:3072 sc1
    s_add_u32 s22, s22, 4096
    s_sub_u32 s11, s22, 57344
    s_cmp_ge_u32 s22, s23
    s_cselect_b32 s22, s11, s22
    v_mfma_f32_32x32x16_bf16 v[112:127], v[212:215], v[36:39], v[112:127]
    ds_read_b64_tr_b16 v[198:199], v12 offset:34048
    s_waitcnt vmcnt(12)
    v_mfma_f32_32x32x16_bf16 v[64:79], v[216:219], v[40:43], v[64:79]
    ds_read_b64_tr_b16 v[200:201], v12 offset:34816
    buffer_load_dwordx4 v[32:35], v8, s[44:47], s22 offen offset:0 sc1
    v_mfma_f32_32x32x16_bf16 v[80:95], v[216:219], v[44:47], v[80:95]
    ds_read_b64_tr_b16 v[202:203], v12 offset:35840
    v_mfma_f32_32x32x16_bf16 v[96:111], v[220:223], v[40:43], v[96:111]
    ds_read_b64_tr_b16 v[204:205], v12 offset:35072
    buffer_load_dwordx4 v[36:39], v8, s[44:47], s22 offen offset:1024 sc1
    v_mfma_f32_32x32x16_bf16 v[112:127], v[220:223], v[44:47], v[112:127]
    ds_read_b64_tr_b16 v[206:207], v12 offset:36096
    s_waitcnt lgkmcnt(15)
    s_waitcnt vmcnt(12)
    v_mfma_f32_32x32x16_bf16 v[64:79], v[128:131], v[48:51], v[64:79]
    ds_read_b64_tr_b16 v[208:209], v12 offset:49152
    buffer_load_dwordx4 v[40:43], v8, s[44:47], s22 offen offset:2048 sc1
    v_mfma_f32_32x32x16_bf16 v[80:95], v[128:131], v[52:55], v[80:95]
    ds_read_b64_tr_b16 v[210:211], v12 offset:50176
    v_mfma_f32_32x32x16_bf16 v[96:111], v[132:135], v[48:51], v[96:111]
    ds_read_b64_tr_b16 v[212:213], v12 offset:49408
    buffer_load_dwordx4 v[44:47], v8, s[44:47], s22 offen offset:3072 sc1
    s_add_u32 s22, s22, 4096
    s_sub_u32 s11, s22, 57344
    s_cmp_ge_u32 s22, s23
    s_cselect_b32 s22, s11, s22
    v_mfma_f32_32x32x16_bf16 v[112:127], v[132:135], v[52:55], v[112:127]
    ds_read_b64_tr_b16 v[214:215], v12 offset:50432
    s_waitcnt vmcnt(12)
    v_mfma_f32_32x32x16_bf16 v[64:79], v[136:139], v[56:59], v[64:79]
    ds_read_b64_tr_b16 v[216:217], v12 offset:51200
    buffer_load_dwordx4 v[48:51], v8, s[44:47], s22 offen offset:0 sc1
    v_mfma_f32_32x32x16_bf16 v[80:95], v[136:139], v[60:63], v[80:95]
    ds_read_b64_tr_b16 v[218:219], v12 offset:52224
    v_mfma_f32_32x32x16_bf16 v[96:111], v[140:143], v[56:59], v[96:111]
    ds_read_b64_tr_b16 v[220:221], v12 offset:51456
    buffer_load_dwordx4 v[52:55], v8, s[44:47], s22 offen offset:1024 sc1
    v_mfma_f32_32x32x16_bf16 v[112:127], v[140:143], v[60:63], v[112:127]
    ds_read_b64_tr_b16 v[222:223], v12 offset:52480
    s_waitcnt vmcnt(12)
    v_mfma_f32_32x32x16_bf16 v[64:79], v[144:147], v[224:227], v[64:79]
    ds_read_b64_tr_b16 v[128:129], v13 offset:0
    buffer_load_dwordx4 v[56:59], v8, s[44:47], s22 offen offset:2048 sc1
    v_mfma_f32_32x32x16_bf16 v[80:95], v[144:147], v[228:231], v[80:95]
    ds_read_b64_tr_b16 v[130:131], v13 offset:1024
    v_mfma_f32_32x32x16_bf16 v[96:111], v[148:151], v[224:227], v[96:111]
    ds_read_b64_tr_b16 v[132:133], v13 offset:256
    buffer_load_dwordx4 v[60:63], v8, s[44:47], s22 offen offset:3072 sc1
    s_add_u32 s22, s22, 4096
    s_sub_u32 s11, s22, 57344
    s_cmp_ge_u32 s22, s23
    s_cselect_b32 s22, s11, s22
    v_mfma_f32_32x32x16_bf16 v[112:127], v[148:151], v[228:231], v[112:127]
    ds_read_b64_tr_b16 v[134:135], v13 offset:1280
    s_waitcnt vmcnt(12)
    v_mfma_f32_32x32x16_bf16 v[64:79], v[152:155], v[232:235], v[64:79]
    ds_read_b64_tr_b16 v[136:137], v13 offset:2048
    buffer_load_dwordx4 v[224:227], v8, s[44:47], s22 offen offset:0 sc1
    v_mfma_f32_32x32x16_bf16 v[80:95], v[152:155], v[236:239], v[80:95]
    ds_read_b64_tr_b16 v[138:139], v13 offset:3072
    v_mfma_f32_32x32x16_bf16 v[96:111], v[156:159], v[232:235], v[96:111]
    ds_read_b64_tr_b16 v[140:141], v13 offset:2304
    buffer_load_dwordx4 v[228:231], v8, s[44:47], s22 offen offset:1024 sc1
    v_mfma_f32_32x32x16_bf16 v[112:127], v[156:159], v[236:239], v[112:127]
    ds_read_b64_tr_b16 v[142:143], v13 offset:3328
    s_waitcnt vmcnt(12)
    v_mfma_f32_32x32x16_bf16 v[64:79], v[160:163], v[16:19], v[64:79]
    ds_read_b64_tr_b16 v[144:145], v13 offset:16384
    buffer_load_dwordx4 v[232:235], v8, s[44:47], s22 offen offset:2048 sc1
    v_mfma_f32_32x32x16_bf16 v[80:95], v[160:163], v[20:23], v[80:95]
    ds_read_b64_tr_b16 v[146:147], v13 offset:17408
    v_mfma_f32_32x32x16_bf16 v[96:111], v[164:167], v[16:19], v[96:111]
    ds_read_b64_tr_b16 v[148:149], v13 offset:16640
    buffer_load_dwordx4 v[236:239], v8, s[44:47], s22 offen offset:3072 sc1
    s_add_u32 s22, s22, 4096
    s_sub_u32 s11, s22, 57344
    s_cmp_ge_u32 s22, s23
    s_cselect_b32 s22, s11, s22
    v_mfma_f32_32x32x16_bf16 v[112:127], v[164:167], v[20:23], v[112:127]
    ds_read_b64_tr_b16 v[150:151], v13 offset:17664
    s_waitcnt vmcnt(12)
    v_mfma_f32_32x32x16_bf16 v[64:79], v[168:171], v[24:27], v[64:79]
    ds_read_b64_tr_b16 v[152:153], v13 offset:18432
    buffer_load_dwordx4 v[16:19], v8, s[44:47], s22 offen offset:0 sc1
    v_mfma_f32_32x32x16_bf16 v[80:95], v[168:171], v[28:31], v[80:95]
    ds_read_b64_tr_b16 v[154:155], v13 offset:19456
    v_mfma_f32_32x32x16_bf16 v[96:111], v[172:175], v[24:27], v[96:111]
    ds_read_b64_tr_b16 v[156:157], v13 offset:18688
    buffer_load_dwordx4 v[20:23], v8, s[44:47], s22 offen offset:1024 sc1
    v_mfma_f32_32x32x16_bf16 v[112:127], v[172:175], v[28:31], v[112:127]
    ds_read_b64_tr_b16 v[158:159], v13 offset:19712
    s_waitcnt lgkmcnt(15)
    s_waitcnt vmcnt(12)
    v_mfma_f32_32x32x16_bf16 v[64:79], v[176:179], v[32:35], v[64:79]
    buffer_load_dwordx4 v[24:27], v8, s[44:47], s22 offen offset:2048 sc1
    v_mfma_f32_32x32x16_bf16 v[80:95], v[176:179], v[36:39], v[80:95]
    v_mfma_f32_32x32x16_bf16 v[96:111], v[180:183], v[32:35], v[96:111]
    buffer_load_dwordx4 v[28:31], v8, s[44:47], s22 offen offset:3072 sc1
    s_add_u32 s22, s22, 4096
    s_sub_u32 s11, s22, 57344
    s_cmp_ge_u32 s22, s23
    s_cselect_b32 s22, s11, s22
    v_mfma_f32_32x32x16_bf16 v[112:127], v[180:183], v[36:39], v[112:127]
    s_waitcnt vmcnt(12)
    v_mfma_f32_32x32x16_bf16 v[64:79], v[184:187], v[40:43], v[64:79]
    buffer_load_dwordx4 v[32:35], v8, s[44:47], s22 offen offset:0 sc1
    v_mfma_f32_32x32x16_bf16 v[80:95], v[184:187], v[44:47], v[80:95]
    v_mfma_f32_32x32x16_bf16 v[96:111], v[188:191], v[40:43], v[96:111]
    buffer_load_dwordx4 v[36:39], v8, s[44:47], s22 offen offset:1024 sc1
    v_mfma_f32_32x32x16_bf16 v[112:127], v[188:191], v[44:47], v[112:127]
    s_waitcnt vmcnt(12)
    v_mfma_f32_32x32x16_bf16 v[64:79], v[192:195], v[48:51], v[64:79]
    buffer_load_dwordx4 v[40:43], v8, s[44:47], s22 offen offset:2048 sc1
    v_mfma_f32_32x32x16_bf16 v[80:95], v[192:195], v[52:55], v[80:95]
    v_mfma_f32_32x32x16_bf16 v[96:111], v[196:199], v[48:51], v[96:111]
    buffer_load_dwordx4 v[44:47], v8, s[44:47], s22 offen offset:3072 sc1
    s_add_u32 s22, s22, 4096
    s_sub_u32 s11, s22, 57344
    s_cmp_ge_u32 s22, s23
    s_cselect_b32 s22, s11, s22
    v_mfma_f32_32x32x16_bf16 v[112:127], v[196:199], v[52:55], v[112:127]
    s_waitcnt vmcnt(12)
    v_mfma_f32_32x32x16_bf16 v[64:79], v[200:203], v[56:59], v[64:79]
    v_mfma_f32_32x32x16_bf16 v[80:95], v[200:203], v[60:63], v[80:95]
    v_mfma_f32_32x32x16_bf16 v[96:111], v[204:207], v[56:59], v[96:111]
    v_mfma_f32_32x32x16_bf16 v[112:127], v[204:207], v[60:63], v[112:127]
    s_waitcnt vmcnt(10)
    v_mfma_f32_32x32x16_bf16 v[64:79], v[208:211], v[224:227], v[64:79]
    v_mfma_f32_32x32x16_bf16 v[80:95], v[208:211], v[228:231], v[80:95]
    v_mfma_f32_32x32x16_bf16 v[96:111], v[212:215], v[224:227], v[96:111]
    v_mfma_f32_32x32x16_bf16 v[112:127], v[212:215], v[228:231], v[112:127]
    s_waitcnt vmcnt(8)
    v_mfma_f32_32x32x16_bf16 v[64:79], v[216:219], v[232:235], v[64:79]
    v_mfma_f32_32x32x16_bf16 v[80:95], v[216:219], v[236:239], v[80:95]
    v_mfma_f32_32x32x16_bf16 v[96:111], v[220:223], v[232:235], v[96:111]
    v_mfma_f32_32x32x16_bf16 v[112:127], v[220:223], v[236:239], v[112:127]
    v_and_b32 v2, 7, v9
    v_xor_b32 v2, v2, v10
    v_lshlrev_b32 v2, 4, v2
    v_lshl_add_u32 v2, v3, 8, v2
    v_bfe_u32 v15, v1, 4, 1
    v_lshl_add_u32 v2, v15, 14, v2
    s_waitcnt vmcnt(0) lgkmcnt(0)
    v_add_u32 v12, s15, v2
    v_xor_b32 v13, 32, v12
    v_xor_b32 v14, 64, v12
    v_xor_b32 v15, 96, v12
    v_mfma_f32_32x32x16_bf16 v[64:79], v[128:131], v[16:19], v[64:79]
    v_mfma_f32_32x32x16_bf16 v[64:79], v[136:139], v[24:27], v[64:79]
    v_mfma_f32_32x32x16_bf16 v[64:79], v[144:147], v[32:35], v[64:79]
    v_mfma_f32_32x32x16_bf16 v[64:79], v[152:155], v[40:43], v[64:79]
    v_mfma_f32_32x32x16_bf16 v[96:111], v[132:135], v[16:19], v[96:111]
    v_mfma_f32_32x32x16_bf16 v[96:111], v[140:143], v[24:27], v[96:111]
    s_nop 9
    ds_write_b128 v12, v[64:67] offset:0
    ds_write_b128 v13, v[68:71] offset:0
    v_mfma_f32_32x32x16_bf16 v[96:111], v[148:151], v[32:35], v[96:111]
    ds_write_b128 v14, v[72:75] offset:0
    ds_write_b128 v15, v[76:79] offset:0
    v_mfma_f32_32x32x16_bf16 v[96:111], v[156:159], v[40:43], v[96:111]
    v_mfma_f32_32x32x16_bf16 v[80:95], v[128:131], v[20:23], v[80:95]
    v_mfma_f32_32x32x16_bf16 v[80:95], v[136:139], v[28:31], v[80:95]
    s_nop 9
    ds_write_b128 v12, v[96:99] offset:128
    ds_write_b128 v13, v[100:103] offset:128
    v_mfma_f32_32x32x16_bf16 v[80:95], v[144:147], v[36:39], v[80:95]
    ds_write_b128 v14, v[104:107] offset:128
    ds_write_b128 v15, v[108:111] offset:128
    v_mfma_f32_32x32x16_bf16 v[80:95], v[152:155], v[44:47], v[80:95]
    v_mfma_f32_32x32x16_bf16 v[112:127], v[132:135], v[20:23], v[112:127]
    v_mfma_f32_32x32x16_bf16 v[112:127], v[140:143], v[28:31], v[112:127]
    s_nop 9
    ds_write_b128 v12, v[80:83] offset:32768
    ds_write_b128 v13, v[84:87] offset:32768
    v_mfma_f32_32x32x16_bf16 v[112:127], v[148:151], v[36:39], v[112:127]
    ds_write_b128 v14, v[88:91] offset:32768
    ds_write_b128 v15, v[92:95] offset:32768
    v_mfma_f32_32x32x16_bf16 v[112:127], v[156:159], v[44:47], v[112:127]
    s_nop 11
    ds_write_b128 v12, v[112:115] offset:32896
    ds_write_b128 v13, v[116:119] offset:32896
    ds_write_b128 v14, v[120:123] offset:32896
    ds_write_b128 v15, v[124:127] offset:32896
    s_waitcnt lgkmcnt(0)
    s_barrier
    s_endpgm
L_g_helper:
    ds_write_b32 v60, v62 offset:48
    ds_write_b32 v60, v62 offset:304
    ds_write_b32 v60, v62 offset:224
    ds_write_b32 v60, v62 offset:240
    ds_write_b32 v60, v62 offset:32
    ds_write_b32 v60, v62 offset:64
    s_waitcnt vmcnt(0)
    v_perm_b32 v28, v176, v177, s16
    v_perm_b32 v29, v177, v178, s16
    v_perm_b32 v30, v178, v179, s16
    v_perm_b32 v31, v179, v180, s16
    v_perm_b32 v32, v180, v181, s16
    v_perm_b32 v33, v181, v182, s16
    v_perm_b32 v34, v182, v183, s16
    v_perm_b32 v35, v183, v184, s16
    v_perm_b32 v36, v184, v185, s16
    v_perm_b32 v37, v185, v186, s16
    v_dot2_f32_bf16 v38, v30, v196, 0
    v_dot2_f32_bf16 v39, v31, v196, 0
    v_dot2_f32_bf16 v40, v32, v196, 0
    v_dot2_f32_bf16 v41, v33, v196, 0
    v_dot2_f32_bf16 v42, v34, v196, 0
    v_dot2_f32_bf16 v43, v35, v196, 0
    v_dot2_f32_bf16 v44, v36, v196, 0
    v_dot2_f32_bf16 v45, v37, v196, 0
    v_dot2_f32_bf16 v38, v28, v197, v38
    v_dot2_f32_bf16 v39, v29, v197, v39
    v_dot2_f32_bf16 v40, v30, v197, v40
    v_dot2_f32_bf16 v41, v31, v197, v41
    v_dot2_f32_bf16 v42, v32, v197, v42
    v_dot2_f32_bf16 v43, v33, v197, v43
    v_dot2_f32_bf16 v44, v34, v197, v44
    v_dot2_f32_bf16 v45, v35, v197, v45
    v_lshlrev_b32 v46, 16, v187
    v_lshlrev_b32 v47, 16, v188
    v_lshlrev_b32 v48, 16, v189
    v_lshlrev_b32 v49, 16, v190
    v_lshlrev_b32 v50, 16, v191
    v_lshlrev_b32 v51, 16, v192
    v_lshlrev_b32 v52, 16, v193
    v_lshlrev_b32 v53, 16, v194
    v_pk_mul_f32 v[38:39], v[38:39], v[46:47]
    v_pk_mul_f32 v[40:41], v[40:41], v[48:49]
    v_pk_mul_f32 v[42:43], v[42:43], v[50:51]
    v_pk_mul_f32 v[44:45], v[44:45], v[52:53]
    v_cvt_pk_bf16_f32 v224, v45, v44
    v_cvt_pk_bf16_f32 v225, v43, v42
    v_cvt_pk_bf16_f32 v226, v41, v40
    v_cvt_pk_bf16_f32 v227, v39, v38
    ds_write_b128 v203, v[224:227] offset:0
    v_perm_b32 v28, v176, v177, s17
    v_perm_b32 v29, v177, v178, s17
    v_perm_b32 v30, v178, v179, s17
    v_perm_b32 v31, v179, v180, s17
    v_perm_b32 v32, v180, v181, s17
    v_perm_b32 v33, v181, v182, s17
    v_perm_b32 v34, v182, v183, s17
    v_perm_b32 v35, v183, v184, s17
    v_perm_b32 v36, v184, v185, s17
    v_perm_b32 v37, v185, v186, s17
    v_dot2_f32_bf16 v38, v30, v198, 0
    v_dot2_f32_bf16 v39, v31, v198, 0
    v_dot2_f32_bf16 v40, v32, v198, 0
    v_dot2_f32_bf16 v41, v33, v198, 0
    v_dot2_f32_bf16 v42, v34, v198, 0
    v_dot2_f32_bf16 v43, v35, v198, 0
    v_dot2_f32_bf16 v44, v36, v198, 0
    v_dot2_f32_bf16 v45, v37, v198, 0
    v_dot2_f32_bf16 v38, v28, v199, v38
    v_dot2_f32_bf16 v39, v29, v199, v39
    v_dot2_f32_bf16 v40, v30, v199, v40
    v_dot2_f32_bf16 v41, v31, v199, v41
    v_dot2_f32_bf16 v42, v32, v199, v42
    v_dot2_f32_bf16 v43, v33, v199, v43
    v_dot2_f32_bf16 v44, v34, v199, v44
    v_dot2_f32_bf16 v45, v35, v199, v45
    v_and_b32 v46, s92, v187
    v_and_b32 v47, s92, v188
    v_and_b32 v48, s92, v189
    v_and_b32 v49, s92, v190
    v_and_b32 v50, s92, v191
    v_and_b32 v51, s92, v192
    v_and_b32 v52, s92, v193
    v_and_b32 v53, s92, v194
    v_pk_mul_f32 v[38:39], v[38:39], v[46:47]
    v_pk_mul_f32 v[40:41], v[40:41], v[48:49]
    v_pk_mul_f32 v[42:43], v[42:43], v[50:51]
    v_pk_mul_f32 v[44:45], v[44:45], v[52:53]
    v_cvt_pk_bf16_f32 v228, v45, v44
    v_cvt_pk_bf16_f32 v229, v43, v42
    v_cvt_pk_bf16_f32 v230, v41, v40
    v_cvt_pk_bf16_f32 v231, v39, v38
    ds_write_b128 v203, v[228:231] offset:128
    s_waitcnt lgkmcnt(0)
    s_barrier
    ds_read_b128 v[176:179], v204
    ds_read_b128 v[180:183], v205 offset:1024
    s_waitcnt lgkmcnt(0)
    buffer_store_dwordx4 v[176:179], v206, s[44:47], s32 offen sc1
    buffer_store_dwordx4 v[180:183], v206, s[44:47], s33 offen sc1
    s_barrier
    s_waitcnt vmcnt(0)
    s_barrier
    s_cmp_lg_u32 s13, 0
    s_cbranch_scc1 L_h_nofk
    v_lshlrev_b32 v2, 12, v1
    s_mov_b64 exec, 0xff
    buffer_store_dword v62, v2, s[44:47], s34 offen sc1
    s_mov_b64 exec, -1
L_h_nofk:
    s_lshl_b32 s15, s13, 12
    s_mul_i32 s23, s13, 14
    s_add_u32 s22, s23, s12
    s_lshl_b32 s22, s22, 15
    s_add_u32 s23, s23, 14
    s_lshl_b32 s23, s23, 15
    s_mov_b32 s100, 400000
L_lw_46:
    ds_read_b32 v2, v60 offset:384
    s_waitcnt lgkmcnt(0)
    v_cmp_ne_u32 vcc, s96, v2
    s_cbranch_vccz L_lwd_47
    s_sub_u32 s100, s100, 1
    s_cbranch_scc1 L_lwd_47
    s_sleep 1
    s_branch L_lw_46
L_lwd_47:
    s_add_u32 m0, s15, 0
    s_add_u32 s11, s22, 0
    buffer_load_dwordx4 v11, s[52:55], s11 offen lds
    s_add_u32 m0, s15, 1024
    s_add_u32 s11, s22, 8192
    buffer_load_dwordx4 v11, s[52:55], s11 offen lds
    s_add_u32 m0, s15, 2048
    s_add_u32 s11, s22, 16384
    buffer_load_dwordx4 v11, s[52:55], s11 offen lds
    s_add_u32 m0, s15, 3072
    s_add_u32 s11, s22, 24576
    buffer_load_dwordx4 v11, s[52:55], s11 offen lds
    s_add_u32 s22, s22, 32768
    s_sub_u32 s11, s22, 458752
    s_cmp_ge_u32 s22, s23
    s_cselect_b32 s22, s11, s22
    s_add_u32 m0, s15, 16384
    s_add_u32 s11, s22, 0
    buffer_load_dwordx4 v11, s[52:55], s11 offen lds
    s_add_u32 m0, s15, 17408
    s_add_u32 s11, s22, 8192
    buffer_load_dwordx4 v11, s[52:55], s11 offen lds
    s_add_u32 m0, s15, 18432
    s_add_u32 s11, s22, 16384
    buffer_load_dwordx4 v11, s[52:55], s11 offen lds
    s_add_u32 m0, s15, 19456
    s_add_u32 s11, s22, 24576
    buffer_load_dwordx4 v11, s[52:55], s11 offen lds
    s_add_u32 s22, s22, 32768
    s_sub_u32 s11, s22, 458752
    s_cmp_ge_u32 s22, s23
    s_cselect_b32 s22, s11, s22
    s_add_u32 m0, s15, 32768
    s_add_u32 s11, s22, 0
    buffer_load_dwordx4 v11, s[52:55], s11 offen lds
    s_add_u32 m0, s15, 33792
    s_add_u32 s11, s22, 8192
    buffer_load_dwordx4 v11, s[52:55], s11 offen lds
    s_add_u32 m0, s15, 34816
    s_add_u32 s11, s22, 16384
    buffer_load_dwordx4 v11, s[52:55], s11 offen lds
    s_add_u32 m0, s15, 35840
    s_add_u32 s11, s22, 24576
    buffer_load_dwordx4 v11, s[52:55], s11 offen lds
    s_add_u32 s22, s22, 32768
    s_sub_u32 s11, s22, 458752
    s_cmp_ge_u32 s22, s23
    s_cselect_b32 s22, s11, s22
    s_add_u32 m0, s15, 49152
    s_add_u32 s11, s22, 0
    buffer_load_dwordx4 v11, s[52:55], s11 offen lds
    s_add_u32 m0, s15, 50176
    s_add_u32 s11, s22, 8192
    buffer_load_dwordx4 v11, s[52:55], s11 offen lds
    s_add_u32 m0, s15, 51200
    s_add_u32 s11, s22, 16384
    buffer_load_dwordx4 v11, s[52:55], s11 offen lds
    s_add_u32 m0, s15, 52224
    s_add_u32 s11, s22, 24576
    buffer_load_dwordx4 v11, s[52:55], s11 offen lds
    s_add_u32 s22, s22, 32768
    s_sub_u32 s11, s22, 458752
    s_cmp_ge_u32 s22, s23
    s_cselect_b32 s22, s11, s22
    s_add_u32 m0, s15, 65536
    s_add_u32 s11, s22, 0
    buffer_load_dwordx4 v11, s[52:55], s11 offen lds
    s_add_u32 m0, s15, 66560
    s_add_u32 s11, s22, 8192
    buffer_load_dwordx4 v11, s[52:55], s11 offen lds
    s_add_u32 m0, s15, 67584
    s_add_u32 s11, s22, 16384
    buffer_load_dwordx4 v11, s[52:55], s11 offen lds
    s_add_u32 m0, s15, 68608
    s_add_u32 s11, s22, 24576
    buffer_load_dwordx4 v11, s[52:55], s11 offen lds
    s_add_u32 s22, s22, 32768
    s_sub_u32 s11, s22, 458752
    s_cmp_ge_u32 s22, s23
    s_cselect_b32 s22, s11, s22
    s_add_u32 m0, s15, 81920
    s_add_u32 s11, s22, 0
    buffer_load_dwordx4 v11, s[52:55], s11 offen lds
    s_add_u32 m0, s15, 82944
    s_add_u32 s11, s22, 8192
    buffer_load_dwordx4 v11, s[52:55], s11 offen lds
    s_add_u32 m0, s15, 83968
    s_add_u32 s11, s22, 16384
    buffer_load_dwordx4 v11, s[52:55], s11 offen lds
    s_add_u32 m0, s15, 84992
    s_add_u32 s11, s22, 24576
    buffer_load_dwordx4 v11, s[52:55], s11 offen lds
    s_add_u32 s22, s22, 32768
    s_sub_u32 s11, s22, 458752
    s_cmp_ge_u32 s22, s23
    s_cselect_b32 s22, s11, s22
    s_add_u32 m0, s15, 98304
    s_add_u32 s11, s22, 0
    buffer_load_dwordx4 v11, s[52:55], s11 offen lds
    s_add_u32 m0, s15, 99328
    s_add_u32 s11, s22, 8192
    buffer_load_dwordx4 v11, s[52:55], s11 offen lds
    s_add_u32 m0, s15, 100352
    s_add_u32 s11, s22, 16384
    buffer_load_dwordx4 v11, s[52:55], s11 offen lds
    s_add_u32 m0, s15, 101376
    s_add_u32 s11, s22, 24576
    buffer_load_dwordx4 v11, s[52:55], s11 offen lds
    s_add_u32 s22, s22, 32768
    s_sub_u32 s11, s22, 458752
    s_cmp_ge_u32 s22, s23
    s_cselect_b32 s22, s11, s22
    s_add_u32 m0, s15, 114688
    s_add_u32 s11, s22, 0
    buffer_load_dwordx4 v11, s[52:55], s11 offen lds
    s_add_u32 m0, s15, 115712
    s_add_u32 s11, s22, 8192
    buffer_load_dwordx4 v11, s[52:55], s11 offen lds
    s_add_u32 m0, s15, 116736
    s_add_u32 s11, s22, 16384
    buffer_load_dwordx4 v11, s[52:55], s11 offen lds
    s_add_u32 m0, s15, 117760
    s_add_u32 s11, s22, 24576
    buffer_load_dwordx4 v11, s[52:55], s11 offen lds
    s_add_u32 s22, s22, 32768
    s_sub_u32 s11, s22, 458752
    s_cmp_ge_u32 s22, s23
    s_cselect_b32 s22, s11, s22
    s_lshl_b32 s15, s13, 12
    s_mul_i32 s17, s13, 14
    s_add_u32 s16, s17, s12
    s_lshl_b32 s16, s16, 15
    s_add_u32 s17, s17, 14
    s_lshl_b32 s17, s17, 15
    s_add_u32 s16, s16, 131072
    s_sub_u32 s11, s16, 458752
    s_cmp_ge_u32 s16, s17
    s_cselect_b32 s16, s11, s16
    s_mov_b32 s30, s16
    s_add_u32 s16, s16, 32768
    s_sub_u32 s11, s16, 458752
    s_cmp_ge_u32 s16, s17
    s_cselect_b32 s16, s11, s16
    s_mov_b32 s31, s16
    s_add_u32 s16, s16, 32768
    s_sub_u32 s11, s16, 458752
    s_cmp_ge_u32 s16, s17
    s_cselect_b32 s16, s11, s16
    s_mov_b32 s32, s16
    s_add_u32 s16, s16, 32768
    s_sub_u32 s11, s16, 458752
    s_cmp_ge_u32 s16, s17
    s_cselect_b32 s16, s11, s16
    s_mov_b32 s33, s16
    s_add_u32 s16, s16, 32768
    s_sub_u32 s11, s16, 458752
    s_cmp_ge_u32 s16, s17
    s_cselect_b32 s16, s11, s16
    s_mov_b32 s34, s16
    s_add_u32 s16, s16, 32768
    s_sub_u32 s11, s16, 458752
    s_cmp_ge_u32 s16, s17
    s_cselect_b32 s16, s11, s16
    s_mov_b32 s35, s16
    s_add_u32 s16, s16, 32768
    s_sub_u32 s11, s16, 458752
    s_cmp_ge_u32 s16, s17
    s_cselect_b32 s16, s11, s16
    s_mov_b32 s36, s16
    s_add_u32 s16, s16, 32768
    s_sub_u32 s11, s16, 458752
    s_cmp_ge_u32 s16, s17
    s_cselect_b32 s16, s11, s16
    s_mov_b32 s37, s16
    s_add_u32 s16, s16, 32768
    s_sub_u32 s11, s16, 458752
    s_cmp_ge_u32 s16, s17
    s_cselect_b32 s16, s11, s16
    s_mov_b32 s38, s16
    s_add_u32 s16, s16, 32768
    s_sub_u32 s11, s16, 458752
    s_cmp_ge_u32 s16, s17
    s_cselect_b32 s16, s11, s16
    s_mov_b32 s39, s16
    v_lshl_add_u32 v12, v10, 9, v21
    v_add_u32 v12, s15, v12
    v_add_u32 v13, 0x10000, v12
    s_mul_i32 s23, s8, 56
    s_mul_i32 s11, s13, 14
    s_add_u32 s23, s23, s11
    s_add_u32 s22, s23, s12
    s_add_u32 s23, s23, 14
    s_lshl_b32 s22, s22, 12
    s_lshl_b32 s23, s23, 12
    s_add_u32 s22, s22, 4521984
    s_add_u32 s23, s23, 4521984
    s_lshl_b32 s24, s8, 2
    s_add_u32 s24, s24, s13
    s_lshl_b32 s24, s24, 7
    s_add_u32 s24, s24, 36864
    s_waitcnt vmcnt(0)
    s_branch L_g_gemm2
L_c_helper:
    s_mov_b32 s46, 12255232
    s_mov_b32 s47, 0x20000
    s_mov_b64 s[44:45], s[42:43]
    s_mov_b32 s74, 2097152
    s_mov_b32 s75, 0x20000
    s_mov_b64 s[72:73], s[24:25]
    s_mov_b32 s78, 1024
    s_mov_b32 s79, 0x20000
    s_mov_b64 s[76:77], s[26:27]
    s_mov_b32 s54, 1835008
    s_mov_b32 s55, 0x20000
    s_mov_b64 s[52:53], s[34:35]
    s_mov_b32 s90, 1024
    s_mov_b32 s91, 0x20000
    s_mov_b64 s[88:89], s[36:37]
    s_mov_b32 s50, 2097152
    s_mov_b32 s51, 0x20000
    s_mov_b64 s[48:49], s[38:39]
    s_lshr_b32 s11, s5, 2
    s_lshr_b32 s14, s4, 1
    s_lshl_b32 s8, s14, 3
    s_add_u32 s8, s8, s11
    s_and_b32 s11, s5, 3
    s_and_b32 s14, s4, 1
    s_lshl_b32 s9, s14, 2
    s_add_u32 s9, s9, s11
    s_mul_i32 s11, s11, 0
    s_add_u32 s11, s11, 1
    s_lshr_b32 s12, s11, 1
    s_mov_b32 s92, 0xffff0000
    v_and_b32 v3, 15, v1
    v_lshrrev_b32 v7, 2, v1
    v_lshlrev_b32 v8, 4, v1
    v_lshl_add_u32 v11, v10, 2, v6
    v_lshlrev_b32 v11, 10, v11
    v_and_b32 v2, 1, v4
    v_lshl_add_u32 v11, v2, 6, v11
    v_lshl_add_u32 v11, v5, 4, v11
    s_lshl_b32 s11, s9, 7
    v_add_u32 v11, s11, v11
    v_lshlrev_b32 v21, 6, v6
    v_lshl_add_u32 v21, v2, 5, v21
    v_lshl_add_u32 v21, v5, 3, v21
    s_lshl_b32 s11, s13, 2
    s_add_u32 s11, s11, 158080
    v_mov_b32 v60, s11
    v_lshlrev_b32 v61, 2, v5
    v_add_u32 v61, 158080, v61
    s_and_b32 s24, s13, 1
    s_lshr_b32 s25, s13, 1
    s_lshl_b32 s26, s2, 1
    s_add_u32 s26, s26, s25
    s_mul_i32 s27, s25, 4224
    s_add_u32 s27, s27, 149632
    s_mul_i32 s28, s13, 4640
    s_add_u32 s28, s28, 131072
    s_mul_i32 s23, s13, 14
    s_add_u32 s22, s23, s12
    s_lshl_b32 s22, s22, 15
    s_add_u32 s23, s23, 14
    s_lshl_b32 s23, s23, 15
    s_lshl_b32 s29, s9, 7
    v_and_b32 v17, 1, v4
    v_mul_u32_u24 v17, 4224, v17
    v_lshl_add_u32 v17, v3, 2, v17
    v_add_u32 v17, 149632, v17
    v_mov_b32 v44, 0
    v_mov_b32 v45, 0
    v_mov_b32 v46, 0
    v_mov_b32 v47, 0
    ds_write_b32 v17, v44
    s_lshr_b32 s18, s2, 5
    s_lshl_b32 s18, s18, 7
    s_lshl_b32 s11, s4, 12
    s_add_u32 s18, s18, s11
    s_add_u32 s18, s18, 4096
    s_add_u32 s19, s18, 64
    s_mul_i32 s35, s26, 4224
    s_lshl_b32 s14, s24, 11
    s_add_u32 s35, s35, s14
    s_add_u32 s35, s35, 262144
    s_mul_i32 s36, s25, 9280
    s_add_u32 s36, s36, s14
    s_add_u32 s36, s36, 131072
    v_add_u32 v32, s36, v8
    s_add_u32 s36, s36, 4640
    v_add_u32 v30, s28, v8
    s_xor_b32 s21, s13, 1
    s_mul_i32 s21, s21, 4640
    s_add_u32 s21, s21, 131072
    v_add_u32 v26, s21, v8
    v_xor_b32 v25, 4, v60
    v_lshlrev_b32 v33, 2, v3
    v_lshl_add_u32 v33, v4, 4, v33
    s_lshl_b32 s14, s24, 8
    s_add_u32 s11, s27, s14
    s_add_u32 s11, s11, 4
    v_add_u32 v33, s11, v33
    v_add_u32 v34, 1024, v33
    v_add_u32 v35, 2048, v33
    v_add_u32 v36, 3072, v33
    v_lshrrev_b32 v37, 1, v3
    v_sub_u32 v37, 7, v37
    v_lshlrev_b32 v37, 6, v37
    v_lshl_add_u32 v37, v4, 4, v37
    v_and_b32 v2, 1, v1
    v_mul_u32_u24 v2, 4640, v2
    v_add_u32 v37, v37, v2
    s_mul_i32 s11, s25, 9280
    s_add_u32 s11, s11, s14
    s_add_u32 s11, s11, 131072
    v_add_u32 v37, s11, v37
    v_lshlrev_b32 v27, 3, v1
    v_add_u32 v27, s28, v27
    v_lshrrev_b32 v42, 3, v1
    s_lshl_b32 s11, s13, 3
    v_add_u32 v42, s11, v42
    v_and_b32 v39, 7, v1
    v_lshlrev_b32 v43, 10, v42
    v_lshl_add_u32 v43, v39, 4, v43
    s_lshl_b32 s30, s8, 16
    s_add_u32 s30, s30, s29
    s_add_u32 s37, s30, 32768
    s_lshl_b32 s31, s8, 12
    s_add_u32 s31, s31, 86048
    v_lshlrev_b32 v31, 6, v42
    s_lshl_b32 s14, s26, 1
    buffer_load_ushort v40, off, s[76:79], s14
    v_lshlrev_b32 v2, 4, v39
    buffer_load_dwordx4 v[240:243], v2, s[88:91], s29 offen
    s_waitcnt lgkmcnt(0)
    s_mul_i32 s96, s96, 1664525
    s_add_u32 s96, s96, 1013904223
    s_cmp_eq_u32 s96, 0
    s_cselect_b32 s96, 1013904223, s96
    s_mul_i32 s97, s97, 22695477
    s_add_u32 s97, s97, 0x9e3779b9
    v_mov_b32 v62, s96
    v_mov_b32 v63, s97
    s_sub_u32 s16, s5, 28
    s_lshl_b32 s16, s16, 2
    s_add_u32 s16, s16, s13
    s_lshl_b32 s17, s4, 4
    s_add_u32 s17, s17, s16
    s_mul_i32 s11, s17, 640
    s_add_u32 s11, s11, 4096
    buffer_load_dwordx4 v[120:123], v8, s[44:47], s11 offen
    s_mul_i32 s17, s17, 14336
    buffer_load_dwordx4 v[64:67], v8, s[52:55], s17 offen offset:0
    buffer_load_dwordx4 v[68:71], v8, s[52:55], s17 offen offset:1024
    buffer_load_dwordx4 v[72:75], v8, s[52:55], s17 offen offset:2048
    buffer_load_dwordx4 v[76:79], v8, s[52:55], s17 offen offset:3072
    s_add_u32 s17, s17, 4096
    buffer_load_dwordx4 v[80:83], v8, s[52:55], s17 offen offset:0
    buffer_load_dwordx4 v[84:87], v8, s[52:55], s17 offen offset:1024
    buffer_load_dwordx4 v[88:91], v8, s[52:55], s17 offen offset:2048
    buffer_load_dwordx4 v[92:95], v8, s[52:55], s17 offen offset:3072
    s_add_u32 s17, s17, 4096
    buffer_load_dwordx4 v[96:99], v8, s[52:55], s17 offen offset:0
    buffer_load_dwordx4 v[100:103], v8, s[52:55], s17 offen offset:1024
    buffer_load_dwordx4 v[104:107], v8, s[52:55], s17 offen offset:2048
    buffer_load_dwordx4 v[108:111], v8, s[52:55], s17 offen offset:3072
    s_add_u32 s17, s17, 4096
    buffer_load_dwordx4 v[112:115], v8, s[52:55], s17 offen offset:0
    buffer_load_dwordx4 v[116:119], v8, s[52:55], s17 offen offset:1024
    s_barrier
    s_barrier
    s_barrier
    s_lshl_b32 s17, s16, 17
    s_lshl_b32 s11, s4, 13
    s_add_u32 s17, s17, s11
    buffer_load_dwordx4 v[128:131], v8, s[72:75], s17 offen offset:0
    buffer_load_dwordx4 v[132:135], v8, s[72:75], s17 offen offset:1024
    buffer_load_dwordx4 v[136:139], v8, s[72:75], s17 offen offset:2048
    buffer_load_dwordx4 v[140:143], v8, s[72:75], s17 offen offset:3072
    s_add_u32 s17, s17, 4096
    buffer_load_dwordx4 v[144:147], v8, s[72:75], s17 offen offset:0
    buffer_load_dwordx4 v[148:151], v8, s[72:75], s17 offen offset:1024
    buffer_load_dwordx4 v[152:155], v8, s[72:75], s17 offen offset:2048
    buffer_load_dwordx4 v[156:159], v8, s[72:75], s17 offen offset:3072
    s_add_u32 s17, s17, 61440
    buffer_load_dwordx4 v[160:163], v8, s[72:75], s17 offen offset:0
    buffer_load_dwordx4 v[164:167], v8, s[72:75], s17 offen offset:1024
    buffer_load_dwordx4 v[168:171], v8, s[72:75], s17 offen offset:2048
    buffer_load_dwordx4 v[172:175], v8, s[72:75], s17 offen offset:3072
    s_add_u32 s17, s17, 4096
    buffer_load_dwordx4 v[176:179], v8, s[72:75], s17 offen offset:0
    buffer_load_dwordx4 v[180:183], v8, s[72:75], s17 offen offset:1024
    buffer_load_dwordx4 v[184:187], v8, s[72:75], s17 offen offset:2048
    buffer_load_dwordx4 v[188:191], v8, s[72:75], s17 offen offset:3072
    s_add_u32 s17, s17, 4096
    ds_write_b32 v60, v62 offset:192
    v_lshlrev_b32 v41, 2, v4
    v_add_u32 v41, v41, v3
    v_sub_u32 v41, 15, v41
    s_lshl_b32 s11, s24, 8
    v_add_u32 v41, s11, v41
    v_cmp_eq_u32 vcc, 0, v41
    s_nop 1
    v_cndmask_b32 v244, 0, v40, vcc
    v_cmp_eq_u32 vcc, 1, v41
    s_nop 1
    v_cndmask_b32 v245, 0, v40, vcc
    v_cmp_eq_u32 vcc, 2, v41
    s_nop 1
    v_cndmask_b32 v246, 0, v40, vcc
    v_cmp_eq_u32 vcc, 3, v41
    s_nop 1
    v_cndmask_b32 v247, 0, v40, vcc
    s_lshl_b32 s11, s26, 12
    s_lshl_b32 s14, s24, 11
    s_add_u32 s11, s11, s14
    s_add_u32 s14, s14, s27
    s_add_u32 m0, s14, 64
    s_nop 0
    buffer_load_dwordx4 v8, s[72:75], s11 offen offset:0  lds
    s_lshl_b32 s11, s26, 12
    s_lshl_b32 s14, s24, 11
    s_add_u32 s11, s11, s14
    s_add_u32 s14, s14, s27
    s_add_u32 m0, s14, 64
    s_nop 0
    buffer_load_dwordx4 v8, s[72:75], s11 offen offset:1024  lds
    s_cmp_lg_u32 s13, 1
    s_cbranch_scc1 L_c_fkih
    s_buffer_load_dwordx16 s[60:75], s[44:47], s18 glc
    s_buffer_load_dwordx16 s[76:91], s[44:47], s19 glc
L_c_fkih:
    buffer_load_dwordx4 v[224:227], v43, s[56:59], s30 offen
    buffer_load_dwordx4 v[228:231], v43, s[56:59], s37 offen
    buffer_load_dwordx4 v[232:235], v31, s[44:47], s31 offen sc1
    buffer_load_dwordx4 v[236:239], v31, s[44:47], s31 offen offset:2048 sc1
    s_cmp_lg_u32 s13, 1
    s_cbranch_scc1 L_c_fkwh
    s_mov_b32 s100, 40000
    s_mov_b32 s98, s96
    s_mov_b32 s99, s96
    s_branch L_spw_51
L_spr_50:
    s_sub_u32 s100, s100, 1
    s_cbranch_scc1 L_spd_49
    s_sleep 2
L_sp_48:
    s_buffer_load_dwordx16 s[60:75], s[44:47], s18 glc
    s_buffer_load_dwordx16 s[76:91], s[44:47], s19 glc
L_spw_51:
    s_waitcnt lgkmcnt(0)
    s_cmp_eq_u64 s[60:61], s[98:99]
    s_cbranch_scc0 L_spr_50
    s_cmp_eq_u64 s[62:63], s[98:99]
    s_cbranch_scc0 L_spr_50
    s_cmp_eq_u64 s[64:65], s[98:99]
    s_cbranch_scc0 L_spr_50
    s_cmp_eq_u64 s[66:67], s[98:99]
    s_cbranch_scc0 L_spr_50
    s_cmp_eq_u64 s[68:69], s[98:99]
    s_cbranch_scc0 L_spr_50
    s_cmp_eq_u64 s[70:71], s[98:99]
    s_cbranch_scc0 L_spr_50
    s_cmp_eq_u64 s[72:73], s[98:99]
    s_cbranch_scc0 L_spr_50
    s_cmp_eq_u64 s[74:75], s[98:99]
    s_cbranch_scc0 L_spr_50
    s_cmp_eq_u64 s[76:77], s[98:99]
    s_cbranch_scc0 L_spr_50
    s_cmp_eq_u64 s[78:79], s[98:99]
    s_cbranch_scc0 L_spr_50
    s_cmp_eq_u64 s[80:81], s[98:99]
    s_cbranch_scc0 L_spr_50
    s_cmp_eq_u64 s[82:83], s[98:99]
    s_cbranch_scc0 L_spr_50
    s_cmp_eq_u64 s[84:85], s[98:99]
    s_cbranch_scc0 L_spr_50
    s_cmp_eq_u64 s[86:87], s[98:99]
    s_cbranch_scc0 L_spr_50
    s_cmp_eq_u64 s[88:89], s[98:99]
    s_cbranch_scc0 L_spr_50
    s_cmp_eq_u64 s[90:91], s[98:99]
    s_cbranch_scc0 L_spr_50
L_spd_49:
    ds_write_b32 v60, v62 offset:320
L_c_fkwh:
    v_mov_b32 v41, 158084
    s_mov_b32 s100, 400000
L_lw_52:
    ds_read_b32 v2, v41 offset:320
    s_waitcnt lgkmcnt(0)
    v_cmp_ne_u32 vcc, s96, v2
    s_cbranch_vccz L_lwd_53
    s_sub_u32 s100, s100, 1
    s_cbranch_scc1 L_lwd_53
    s_sleep 1
    s_branch L_lw_52
L_lwd_53:
    s_mov_b32 m0, s36
    ds_write_b64 v27, v[44:45] offset:4096
    buffer_load_dwordx4 v8, s[44:47], s35 offen offset:0 sc1 lds
    buffer_load_dwordx4 v8, s[44:47], s35 offen offset:1024 sc1 lds
    ds_write_b32 v60, v62 offset:384
    s_waitcnt vmcnt(0)
    ds_write_b32 v60, v62 offset:80
    s_mov_b32 s100, 400000
L_lw_54:
    ds_read_b32 v2, v25 offset:80
    s_waitcnt lgkmcnt(0)
    v_cmp_ne_u32 vcc, s96, v2
    s_cbranch_vccz L_lwd_55
    s_sub_u32 s100, s100, 1
    s_cbranch_scc1 L_lwd_55
    s_sleep 1
    s_branch L_lw_54
L_lwd_55:
    ds_read_b128 v[64:67], v32 offset:4640
    ds_read_b32 v68, v32 offset:4656
    ds_read_b128 v[72:75], v32 offset:5664
    ds_read_b32 v76, v32 offset:5680
    s_waitcnt lgkmcnt(0)
    v_alignbyte_b32 v80, v65, v64, 2
    v_alignbyte_b32 v81, v66, v65, 2
    v_alignbyte_b32 v82, v67, v66, 2
    v_alignbyte_b32 v83, v68, v67, 2
    ds_write_b128 v32, v[80:83] offset:0
    v_alignbyte_b32 v84, v73, v72, 2
    v_alignbyte_b32 v85, v74, v73, 2
    v_alignbyte_b32 v86, v75, v74, 2
    v_alignbyte_b32 v87, v76, v75, 2
    ds_write_b128 v32, v[84:87] offset:1024
    ds_write_b32 v60, v62 offset:160
    s_branch L_c_join2
.section .rodata,"a"
.p2align 6
.amdhsa_kernel parallel_sum__ssm_conv_h3__mixer_channel_mlp__prompt_kernel
  .amdhsa_next_free_vgpr 256
  .amdhsa_next_free_sgpr 102
  .amdhsa_accum_offset 256
  .amdhsa_group_segment_fixed_size 0
  .amdhsa_kernarg_size 112
  .amdhsa_user_sgpr_count 2
  .amdhsa_user_sgpr_kernarg_segment_ptr 1
  .amdhsa_system_sgpr_workgroup_id_x 1
  .amdhsa_float_denorm_mode_32 3
  .amdhsa_float_denorm_mode_16_64 3
.end_amdhsa_kernel
```
